```python
import torch

def _softmax(x, axis=-1):
    return torch.softmax(x, dim=axis)
def _gelu(x):
    return torch.nn.functional.gelu(x, approximate="tanh")
def _silu(x):
    return torch.nn.functional.silu(x)
def _sigmoid(x):
    return torch.sigmoid(x)
def _layernorm(x, axis=-1, eps=1e-5):
    m = x.mean(dim=axis, keepdim=True)
    v = x.var(dim=axis, keepdim=True, unbiased=False)
    return (x - m) / torch.sqrt(v + eps)
def _scatter_add(tgt, idx, src, axis=0):
    return tgt.clone().index_add_(axis, idx, src)
def _segment_sum(src, seg, n):
    out = torch.zeros((n,) + src.shape[1:], dtype=src.dtype)
    return out.index_add_(0, seg, src)
def _pad(x, pw):
    flat = tuple(v for pair in reversed(pw) for v in pair)
    return torch.nn.functional.pad(x, flat)

kernel_name = 'standalone__seq2seq_rnn_t_joint__speech'

def setup_inputs():

    _w = (lambda a: (lambda t: t.to(torch.bfloat16) if t.is_floating_point() else t)(torch.as_tensor(a)))
    B, T, D, K = 2, 1000, 512, 3
    U = 8
    sc = (1.0 / (K * D)) ** 0.5
    sd = (1.0 / D) ** 0.5
    return {
        "x": _w((lambda *s: torch.randn(*s, dtype=torch.bfloat16) * 0.4)(B, T, D) * 0.5),
        "w1": _w((lambda *s: torch.randn(*s, dtype=torch.bfloat16) * 3.2)(K, D, D) * sc),
        "w2": _w((lambda *s: torch.randn(*s, dtype=torch.bfloat16) * 3.2)(K, D, D) * sc),
        "g": _w((lambda *s: torch.randn(*s, dtype=torch.bfloat16) * 3.2)(B, U, D) * 0.5),
        "w_f": _w((lambda *s: torch.randn(*s, dtype=torch.bfloat16) * 3.2)(D, D) * sd),
        "w_g": _w((lambda *s: torch.randn(*s, dtype=torch.bfloat16) * 3.2)(D, D) * sd),
        "w_o": _w((lambda *s: torch.randn(*s, dtype=torch.bfloat16) * 3.2)(D, D) * sd),
    }

def reference(x, w1, w2, g, w_f, w_g, w_o):
    B, T, D = x.shape
    K = w1.shape[0]
    pad = K // 2
    xp = _pad(x, ((0,0),(pad,pad),(0,0)))
    h = torch.zeros_like(x)
    for i in range(K):
        h = h + torch.einsum("btc,cd->btd", xp[:, i:i+T, :], w1[i])
    h = _gelu(h)[:, ::2, :]
    T1 = h.shape[1]
    hp = _pad(h, ((0,0),(pad,pad),(0,0)))
    f = torch.zeros_like(h)
    for i in range(K):
        f = f + torch.einsum("btc,cd->btd", hp[:, i:i+T1, :], w2[i])
    f = _gelu(f)[:, ::2, :]
    fe = torch.einsum("btd,de->bte", f, w_f)
    ge = torch.einsum("bud,de->bue", g, w_g)
    j = torch.tanh(fe[:, :, None, :] + ge[:, None, :, :])
    return torch.einsum("btud,dv->btuv", j, w_o)
```

```asm
; @launch grid=(256,1,1) block=(256,1,1) lds=163840
.amdgcn_target "amdgcn-amd-amdhsa--gfx950"
.text
.globl standalone__seq2seq_rnn_t_joint__speech_kernel
.p2align 8
.type standalone__seq2seq_rnn_t_joint__speech_kernel,@function
standalone__seq2seq_rnn_t_joint__speech_kernel:
    s_cmp_ge_u32 s2, 256
    s_cbranch_scc1 L_end
    s_load_dwordx16 s[4:19], s[0:1], 0
    s_load_dwordx4 s[20:23], s[0:1], 64
    v_lshrrev_b32 v2, 6, v0
    v_and_b32 v1, 63, v0
    v_readfirstlane_b32 s64, v2
    s_and_b32 s73, s2, 7
    s_lshr_b32 s74, s2, 3
    s_add_u32 s71, s74, 0
    s_and_b32 s71, s71, 3
    s_lshr_b32 s70, s74, 2
    s_and_b32 s75, s73, 1
    s_lshl_b32 s66, s75, 2
    s_add_u32 s66, s66, s71
    s_lshr_b32 s73, s73, 1
    s_lshl_b32 s65, s73, 3
    s_add_u32 s65, s65, s70
    s_and_b32 s73, s2, 3
    s_lshl_b32 s73, s73, 1
    s_and_b32 s75, s74, 1
    s_add_u32 s66, s73, s75
    s_and_b32 s71, s66, 3
    s_bfe_u32 s73, s2, 0x10002
    s_lshl_b32 s73, s73, 4
    s_lshr_b32 s75, s74, 1
    s_add_u32 s65, s73, s75
    s_and_b32 s70, s65, 7
    s_and_b32 s78, s66, 5
    s_and_b32 s79, s2, 4
    s_or_b32 s78, s78, s79
    s_lshl_b32 s79, s66, 3
    s_add_u32 s79, s79, s65
    s_and_b32 s79, s79, 31
    s_lshr_b32 s67, s65, 4
    s_and_b32 s68, s65, 15
    s_mul_i32 s69, s64, 40960
    v_lshrrev_b32 v2, 4, v1
    v_lshrrev_b32 v3, 5, v1
    v_and_b32 v4, 15, v1
    v_xor_b32 v4, v4, v3
    v_lshlrev_b32 v4, 4, v4
    v_lshl_add_u32 v8, v2, 10, v4
    v_xor_b32 v9, 32, v8
    v_add_u32 v9, 3072, v9
    v_xor_b32 v10, 64, v8
    v_add_u32 v10, 6144, v10
    v_xor_b32 v11, 96, v8
    v_add_u32 v11, 9216, v11
    v_cmp_gt_u32 vcc, 16, v1
    v_bfrev_b32 v2, 1
    v_lshrrev_b32 v3, 3, v1
    v_cndmask_b32 v14, 0, v2, vcc
    v_bfe_u32 v4, v3, 1, 1
    v_lshlrev_b32 v4, 2, v4
    v_and_b32 v5, 7, v1
    v_xor_b32 v4, v4, v5
    v_lshlrev_b32 v4, 4, v4
    v_lshl_add_u32 v15, v3, 10, v4
    v_add_u32 v16, 7168, v15
    s_lshl_b32 s73, s64, 17
    s_lshl_b32 s74, s66, 7
    s_add_u32 s3, s73, s74
    s_mul_i32 s73, s67, 1000
    s_lshl_b32 s74, s68, 6
    s_add_u32 s73, s73, s74
    s_sub_u32 s73, s73, 1
    s_lshl_b32 s73, s73, 10
    s_lshl_b32 s75, s64, 8
    s_add_u32 s73, s73, s75
    s_ashr_i32 s76, s73, 31
    s_sub_u32 s74, 1001, s74
    s_lshl_b32 s74, s74, 10
    s_sub_u32 s26, s74, s75
    s_mov_b32 s27, 0x20000
    s_sub_u32 s30, 1572864, s3
    s_mov_b32 s31, 0x20000
    s_lshl_b32 s72, s70, 14
    s_waitcnt lgkmcnt(0)
    s_add_u32 s24, s4, s73
    s_addc_u32 s25, s5, s76
    s_add_u32 s28, s6, s3
    s_addc_u32 s29, s7, 0
    s_add_u32 s73, s71, 0
    s_and_b32 s73, s73, 3
    s_lshl_b32 s75, s73, 12
    s_add_u32 m0, s75, s69
    s_or_b32 s74, s73, s68
    s_cmp_eq_u32 s74, 0
    s_cselect_b32 s74, -1, 0
    s_and_b32 s76, s73, 1
    s_lshl_b32 s76, s76, 7
    s_lshl_b32 s73, s73, 14
    s_or_b32 s73, s73, s76
    v_xor_b32 v12, s73, v8
    v_and_or_b32 v12, v14, s74, v12
    buffer_load_dwordx4 v12, s[24:27], 0 offen lds
    v_xor_b32 v13, s73, v9
    buffer_load_dwordx4 v13, s[24:27], 0 offen offset:1024 lds
    v_xor_b32 v12, s73, v10
    buffer_load_dwordx4 v12, s[24:27], 0 offen offset:2048 lds
    v_xor_b32 v13, s73, v11
    buffer_load_dwordx4 v13, s[24:27], 0 offen offset:3072 lds
    s_add_u32 m0, s69, 17408
    s_nop 0
    buffer_load_dwordx4 v15, s[28:31], s72 offen lds
    buffer_load_dwordx4 v16, s[28:31], s72 offen offset:1024 lds
    s_add_u32 s74, s72, 524288
    s_add_u32 m0, s69, 19456
    s_nop 0
    buffer_load_dwordx4 v15, s[28:31], s74 offen lds
    buffer_load_dwordx4 v16, s[28:31], s74 offen offset:1024 lds
    s_add_u32 s75, s72, 1048576
    s_add_u32 m0, s69, 21504
    s_nop 0
    buffer_load_dwordx4 v15, s[28:31], s75 offen lds
    buffer_load_dwordx4 v16, s[28:31], s75 offen offset:1024 lds
    s_mov_b32 s60, s22
    s_mov_b32 s61, s23
    s_mov_b32 s62, 4194304
    s_mov_b32 s63, 0x20000
    v_mov_b32 v32, -1
    v_mov_b32 v33, -1
    v_mov_b32 v34, -1
    v_mov_b32 v35, -1
    v_lshlrev_b32 v2, 4, v1
    s_lshl_b32 s73, s65, 14
    s_lshl_b32 s75, s64, 9
    s_add_u32 s73, s73, s75
    s_xor_b32 s74, s66, 1
    s_lshl_b32 s74, s74, 11
    s_add_u32 s75, s73, 1114112
    s_add_u32 s75, s75, s74
    s_xor_b32 s74, s66, 2
    s_lshl_b32 s74, s74, 11
    s_add_u32 s76, s73, s74
    s_lshl_b32 s76, s76, 1
    s_add_u32 s76, s76, 1638400
    s_mov_b32 exec_hi, 0
    buffer_store_dwordx4 v[32:35], v2, s[60:63], s75 offen sc1
    s_mov_b64 exec, -1
    s_lshl_b32 s73, s65, 15
    s_lshl_b32 s74, s66, 11
    s_add_u32 s73, s73, s74
    s_lshr_b32 s74, s64, 1
    s_lshl_b32 s74, s74, 14
    s_add_u32 s73, s73, s74
    s_and_b32 s74, s64, 1
    s_lshl_b32 s74, s74, 10
    s_add_u32 s73, s73, s74
    s_add_u32 s73, s73, 65536
    buffer_store_dwordx4 v[32:35], v2, s[60:63], s73 offen sc1
    s_cmp_lg_u32 s78, 0
    s_cbranch_scc1 L_c0_1
    s_and_b32 s73, s79, 7
    s_lshr_b32 s74, s79, 3
    s_lshl_b32 s75, s73, 14
    s_lshl_b32 s76, s74, 12
    s_add_u32 s75, s75, s76
    s_lshl_b32 s76, s64, 10
    s_add_u32 s75, s75, s76
    s_add_u32 s75, s75, 2752512
    buffer_store_dwordx4 v[32:35], v2, s[60:63], s75 offen sc1
    s_cmp_ge_u32 s64, 2
    s_cbranch_scc1 L_c0_1
    s_lshl_b32 s73, s73, 11
    s_lshl_b32 s74, s74, 9
    s_add_u32 s73, s73, s74
    s_lshl_b32 s74, s64, 14
    s_add_u32 s73, s73, s74
    s_add_u32 s73, s73, 2686976
    s_bfm_b64 exec, 32, 0
    buffer_store_dwordx4 v[32:35], v2, s[60:63], s73 offen sc1
    s_mov_b64 exec, -1
L_c0_1:
    s_add_u32 s73, s71, 1
    s_and_b32 s73, s73, 3
    s_lshl_b32 s75, s73, 12
    s_add_u32 m0, s75, s69
    s_or_b32 s74, s73, s68
    s_cmp_eq_u32 s74, 0
    s_cselect_b32 s74, -1, 0
    s_and_b32 s76, s73, 1
    s_lshl_b32 s76, s76, 7
    s_lshl_b32 s73, s73, 14
    s_or_b32 s73, s73, s76
    v_xor_b32 v12, s73, v8
    v_and_or_b32 v12, v14, s74, v12
    buffer_load_dwordx4 v12, s[24:27], 0 offen lds
    v_xor_b32 v13, s73, v9
    buffer_load_dwordx4 v13, s[24:27], 0 offen offset:1024 lds
    v_xor_b32 v12, s73, v10
    buffer_load_dwordx4 v12, s[24:27], 0 offen offset:2048 lds
    v_xor_b32 v13, s73, v11
    buffer_load_dwordx4 v13, s[24:27], 0 offen offset:3072 lds
    s_add_u32 s73, s71, 2
    s_and_b32 s73, s73, 3
    s_lshl_b32 s75, s73, 12
    s_add_u32 m0, s75, s69
    s_or_b32 s74, s73, s68
    s_cmp_eq_u32 s74, 0
    s_cselect_b32 s74, -1, 0
    s_and_b32 s76, s73, 1
    s_lshl_b32 s76, s76, 7
    s_lshl_b32 s73, s73, 14
    s_or_b32 s73, s73, s76
    v_xor_b32 v12, s73, v8
    v_and_or_b32 v12, v14, s74, v12
    buffer_load_dwordx4 v12, s[24:27], 0 offen lds
    v_xor_b32 v13, s73, v9
    buffer_load_dwordx4 v13, s[24:27], 0 offen offset:1024 lds
    v_xor_b32 v12, s73, v10
    buffer_load_dwordx4 v12, s[24:27], 0 offen offset:2048 lds
    v_xor_b32 v13, s73, v11
    buffer_load_dwordx4 v13, s[24:27], 0 offen offset:3072 lds
    s_add_u32 s73, s71, 3
    s_and_b32 s73, s73, 3
    s_lshl_b32 s75, s73, 12
    s_add_u32 m0, s75, s69
    s_or_b32 s74, s73, s68
    s_cmp_eq_u32 s74, 0
    s_cselect_b32 s74, -1, 0
    s_and_b32 s76, s73, 1
    s_lshl_b32 s76, s76, 7
    s_lshl_b32 s73, s73, 14
    s_or_b32 s73, s73, s76
    v_xor_b32 v12, s73, v8
    v_and_or_b32 v12, v14, s74, v12
    buffer_load_dwordx4 v12, s[24:27], 0 offen lds
    v_xor_b32 v13, s73, v9
    buffer_load_dwordx4 v13, s[24:27], 0 offen offset:1024 lds
    v_xor_b32 v12, s73, v10
    buffer_load_dwordx4 v12, s[24:27], 0 offen offset:2048 lds
    v_xor_b32 v13, s73, v11
    buffer_load_dwordx4 v13, s[24:27], 0 offen offset:3072 lds
    v_lshlrev_b32 v12, 4, v1
    v_add_u32 v12, 65536, v12
    s_add_u32 m0, s69, 16384
    s_mov_b64 exec, 0xffff
    buffer_load_dwordx4 v12, s[24:27], 0 offen lds
    s_mov_b64 exec, -1
    s_xor_b32 s73, s66, 1
    s_lshl_b32 s73, s73, 7
    s_lshl_b32 s74, s64, 17
    s_add_u32 s73, s73, s74
    s_sub_u32 s74, 1572864, s73
    s_add_u32 s32, s8, s73
    s_addc_u32 s33, s9, 0
    s_mov_b32 s34, s74
    s_mov_b32 s35, 0x20000
    s_xor_b32 s73, s66, 2
    s_lshl_b32 s73, s73, 7
    s_lshl_b32 s74, s64, 17
    s_add_u32 s73, s73, s74
    s_sub_u32 s74, 524288, s73
    s_add_u32 s40, s12, s73
    s_addc_u32 s41, s13, 0
    s_mov_b32 s42, s74
    s_mov_b32 s43, 0x20000
    s_and_b32 s73, s79, 7
    s_lshl_b32 s73, s73, 7
    s_lshr_b32 s74, s79, 3
    s_lshl_b32 s74, s74, 17
    s_add_u32 s73, s73, s74
    s_lshl_b32 s74, s64, 15
    s_add_u32 s73, s73, s74
    s_sub_u32 s74, 524288, s73
    s_add_u32 s44, s14, s73
    s_addc_u32 s45, s15, 0
    s_mov_b32 s46, s74
    s_mov_b32 s47, 0x20000
    s_lshr_b32 s73, s79, 3
    s_lshl_b32 s73, s73, 8
    s_lshl_b32 s74, s64, 6
    s_add_u32 s73, s73, s74
    s_sub_u32 s74, 16384, s73
    s_add_u32 s36, s10, s73
    s_addc_u32 s37, s11, 0
    s_mov_b32 s38, s74
    s_mov_b32 s39, 0x20000
    s_lshr_b32 s75, s66, 2
    s_lshl_b32 s73, s75, 9
    s_lshl_b32 s74, s64, 7
    s_add_u32 s73, s73, s74
    s_sub_u32 s74, 524288, s73
    s_add_u32 s48, s16, s73
    s_addc_u32 s49, s17, 0
    s_mov_b32 s50, s74
    s_mov_b32 s51, 0x20000
    s_mul_i32 s73, s67, 2048000
    s_add_u32 s52, s18, s73
    s_addc_u32 s53, s19, 0
    s_mov_b32 s54, 2048000
    s_mov_b32 s55, 0x20000
    s_mov_b32 s56, s20
    s_mov_b32 s57, s21
    s_mov_b32 s58, 256
    s_mov_b32 s59, 0x20000
    s_lshr_b32 s17, s66, 2
    s_add_u32 s13, s70, 0
    s_and_b32 s13, s13, 3
    s_lshl_b32 s13, s13, 10
    s_add_u32 s14, s70, 1
    s_and_b32 s14, s14, 3
    s_lshl_b32 s14, s14, 10
    s_add_u32 s15, s70, 2
    s_and_b32 s15, s15, 3
    s_lshl_b32 s15, s15, 10
    s_add_u32 s16, s70, 3
    s_and_b32 s16, s16, 3
    s_lshl_b32 s16, s16, 10
    v_lshlrev_b32 v2, 4, v1
    v_add_u32 v6, s69, v2
    v_bfe_u32 v2, v1, 2, 2
    v_lshrrev_b32 v3, 5, v1
    v_lshl_add_u32 v3, v3, 3, v2
    v_lshlrev_b32 v3, 7, v3
    v_lshrrev_b32 v4, 1, v2
    v_lshl_add_u32 v3, v4, 6, v3
    v_bfe_u32 v4, v1, 4, 1
    v_lshl_add_u32 v3, v4, 5, v3
    v_and_b32 v4, 3, v1
    v_lshl_add_u32 v3, v4, 3, v3
    v_add_u32 v17, s69, v3
    v_xor_b32 v3, 64, v3
    v_add_u32 v18, s69, v3
    v_and_b32 v2, 31, v1
    v_lshrrev_b32 v3, 5, v1
    v_and_b32 v4, 15, v2
    v_xor_b32 v4, v4, v3
    v_lshlrev_b32 v4, 4, v4
    v_lshl_add_u32 v4, v2, 9, v4
    v_add_u32 v19, s69, v4
    v_add_u32 v20, 256, v19
    v_add_u32 v4, 1, v2
    v_and_b32 v4, 15, v4
    v_xor_b32 v4, v4, v3
    v_lshlrev_b32 v4, 4, v4
    v_lshl_add_u32 v4, v2, 9, v4
    v_add_u32 v4, 512, v4
    v_add_u32 v21, s69, v4
    v_lshrrev_b32 v2, 3, v1
    v_bfe_u32 v3, v2, 1, 1
    v_lshlrev_b32 v3, 1, v3
    v_and_b32 v4, 7, v1
    v_xor_b32 v3, v3, v4
    v_lshlrev_b32 v3, 4, v3
    v_lshl_add_u32 v24, v2, 10, v3
    v_xor_b32 v3, 64, v24
    v_add_u32 v25, 7168, v3
    v_add_u32 v26, 14336, v24
    v_add_u32 v27, 21504, v3
    v_lshrrev_b32 v2, 4, v1
    v_bfe_u32 v3, v1, 2, 2
    v_lshl_add_u32 v4, v2, 3, v3
    v_lshlrev_b32 v4, 7, v4
    v_lshrrev_b32 v3, 1, v3
    v_and_b32 v2, 1, v2
    v_lshl_add_u32 v3, v2, 1, v3
    v_lshl_add_u32 v4, v3, 5, v4
    v_and_b32 v3, 3, v1
    v_lshl_add_u32 v4, v3, 3, v4
    v_add_u32 v28, s69, v4
    v_xor_b32 v2, 32, v4
    v_add_u32 v29, s69, v2
    v_xor_b32 v2, 64, v4
    v_add_u32 v30, s69, v2
    v_xor_b32 v2, 96, v4
    v_add_u32 v31, s69, v2
    v_and_b32 v2, 15, v1
    v_bfe_u32 v3, v1, 4, 1
    v_lshl_add_u32 v2, v2, 1, v3
    v_lshlrev_b32 v2, 4, v2
    v_lshrrev_b32 v3, 5, v1
    v_lshl_add_u32 v2, v3, 10, v2
    s_lshl_b32 s73, s64, 11
    v_add_u32 v7, s73, v2
    s_lshl_b32 s3, s70, 5
    s_add_u32 s72, s72, 16384
    s_and_b32 s72, s72, 0x1c000
    s_add_u32 m0, s69, 23552
    s_nop 0
    buffer_load_dwordx4 v15, s[28:31], s72 offen lds
    buffer_load_dwordx4 v16, s[28:31], s72 offen offset:1024 lds
    s_add_u32 s76, s72, 524288
    s_add_u32 m0, s69, 25600
    s_nop 0
    buffer_load_dwordx4 v15, s[28:31], s76 offen lds
    buffer_load_dwordx4 v16, s[28:31], s76 offen offset:1024 lds
    s_add_u32 s73, s72, 1048576
    s_add_u32 m0, s69, 27648
    s_nop 0
    buffer_load_dwordx4 v15, s[28:31], s73 offen lds
    buffer_load_dwordx4 v16, s[28:31], s73 offen offset:1024 lds
    s_add_u32 s72, s72, 16384
    s_and_b32 s72, s72, 0x1c000
    s_add_u32 m0, s69, 29696
    s_nop 0
    buffer_load_dwordx4 v15, s[28:31], s72 offen lds
    buffer_load_dwordx4 v16, s[28:31], s72 offen offset:1024 lds
    s_add_u32 s74, s72, 524288
    s_add_u32 m0, s69, 31744
    s_nop 0
    buffer_load_dwordx4 v15, s[28:31], s74 offen lds
    buffer_load_dwordx4 v16, s[28:31], s74 offen offset:1024 lds
    s_add_u32 s75, s72, 1048576
    s_add_u32 m0, s69, 33792
    s_nop 0
    buffer_load_dwordx4 v15, s[28:31], s75 offen lds
    buffer_load_dwordx4 v16, s[28:31], s75 offen offset:1024 lds
    s_add_u32 s72, s72, 16384
    s_and_b32 s72, s72, 0x1c000
    s_add_u32 m0, s69, 35840
    s_nop 0
    buffer_load_dwordx4 v15, s[28:31], s72 offen lds
    buffer_load_dwordx4 v16, s[28:31], s72 offen offset:1024 lds
    s_waitcnt vmcnt(14)
    s_barrier
    s_cmp_lg_u32 s64, 0
    s_cbranch_scc1 L_hs_2
    s_and_b32 s73, s2, 3
    s_lshl_b32 s73, s73, 6
    v_mov_b32 v2, s73
    v_mov_b32 v3, 1
    s_mov_b64 exec, 1
    buffer_atomic_add v3, v2, s[56:59], 0 offen sc1
    s_mov_b64 exec, -1
L_hs_2:
    v_xor_b32 v22, s3, v19
    ds_read_b64_tr_b16 v[40:41], v17 offset:17408
    ds_read_b64_tr_b16 v[42:43], v17 offset:17920
    ds_read_b64_tr_b16 v[44:45], v18 offset:17408
    ds_read_b64_tr_b16 v[46:47], v18 offset:17920
    ds_read_b128 v[56:59], v22
    v_xor_b32 v23, s3, v20
    ds_read_b64_tr_b16 v[48:49], v17 offset:19456
    ds_read_b64_tr_b16 v[50:51], v17 offset:19968
    ds_read_b64_tr_b16 v[52:53], v18 offset:19456
    ds_read_b64_tr_b16 v[54:55], v18 offset:19968
    ds_read_b128 v[60:63], v23
    s_waitcnt lgkmcnt(5)
    v_mfma_f32_32x32x16_bf16 v[64:79], v[40:43], v[56:59], 0
    v_mfma_f32_32x32x16_bf16 v[80:95], v[44:47], v[56:59], 0
    s_add_u32 s76, s72, 524288
    s_add_u32 m0, s69, 17408
    s_nop 0
    buffer_load_dwordx4 v15, s[28:31], s76 offen lds
    buffer_load_dwordx4 v16, s[28:31], s76 offen offset:1024 lds
    v_xor_b32 v22, s3, v21
    ds_read_b64_tr_b16 v[40:41], v17 offset:21504
    ds_read_b64_tr_b16 v[42:43], v17 offset:22016
    ds_read_b64_tr_b16 v[44:45], v18 offset:21504
    ds_read_b64_tr_b16 v[46:47], v18 offset:22016
    ds_read_b128 v[56:59], v22
    s_waitcnt lgkmcnt(5)
    v_mfma_f32_32x32x16_bf16 v[64:79], v[48:51], v[60:63], v[64:79]
    v_mfma_f32_32x32x16_bf16 v[80:95], v[52:55], v[60:63], v[80:95]
    s_add_u32 s73, s72, 1048576
    s_add_u32 m0, s69, 19456
    s_nop 0
    buffer_load_dwordx4 v15, s[28:31], s73 offen lds
    buffer_load_dwordx4 v16, s[28:31], s73 offen offset:1024 lds
    s_add_u32 s3, s3, 32
    s_and_b32 s3, s3, 0xe0
    v_xor_b32 v23, s3, v19
    s_waitcnt vmcnt(16)
    ds_read_b64_tr_b16 v[48:49], v17 offset:23552
    ds_read_b64_tr_b16 v[50:51], v17 offset:24064
    ds_read_b64_tr_b16 v[52:53], v18 offset:23552
    ds_read_b64_tr_b16 v[54:55], v18 offset:24064
    ds_read_b128 v[60:63], v23
    s_waitcnt lgkmcnt(5)
    v_mfma_f32_32x32x16_bf16 v[64:79], v[40:43], v[56:59], v[64:79]
    v_mfma_f32_32x32x16_bf16 v[80:95], v[44:47], v[56:59], v[80:95]
    s_add_u32 s72, s72, 16384
    s_and_b32 s72, s72, 0x1c000
    s_add_u32 m0, s69, 21504
    s_nop 0
    buffer_load_dwordx4 v15, s[28:31], s72 offen lds
    buffer_load_dwordx4 v16, s[28:31], s72 offen offset:1024 lds
    v_xor_b32 v22, s3, v20
    s_waitcnt vmcnt(16)
    ds_read_b64_tr_b16 v[40:41], v17 offset:25600
    ds_read_b64_tr_b16 v[42:43], v17 offset:26112
    ds_read_b64_tr_b16 v[44:45], v18 offset:25600
    ds_read_b64_tr_b16 v[46:47], v18 offset:26112
    ds_read_b128 v[56:59], v22
    s_waitcnt lgkmcnt(5)
    v_mfma_f32_32x32x16_bf16 v[64:79], v[48:51], v[60:63], v[64:79]
    v_mfma_f32_32x32x16_bf16 v[80:95], v[52:55], v[60:63], v[80:95]
    s_add_u32 s74, s72, 524288
    s_add_u32 m0, s69, 23552
    s_nop 0
    buffer_load_dwordx4 v15, s[28:31], s74 offen lds
    buffer_load_dwordx4 v16, s[28:31], s74 offen offset:1024 lds
    v_xor_b32 v23, s3, v21
    s_waitcnt vmcnt(16)
    ds_read_b64_tr_b16 v[48:49], v17 offset:27648
    ds_read_b64_tr_b16 v[50:51], v17 offset:28160
    ds_read_b64_tr_b16 v[52:53], v18 offset:27648
    ds_read_b64_tr_b16 v[54:55], v18 offset:28160
    ds_read_b128 v[60:63], v23
    s_waitcnt lgkmcnt(5)
    v_mfma_f32_32x32x16_bf16 v[64:79], v[40:43], v[56:59], v[64:79]
    v_mfma_f32_32x32x16_bf16 v[80:95], v[44:47], v[56:59], v[80:95]
    s_add_u32 s75, s72, 1048576
    s_add_u32 m0, s69, 25600
    s_nop 0
    buffer_load_dwordx4 v15, s[28:31], s75 offen lds
    buffer_load_dwordx4 v16, s[28:31], s75 offen offset:1024 lds
    s_add_u32 s3, s3, 32
    s_and_b32 s3, s3, 0xe0
    v_xor_b32 v22, s3, v19
    s_waitcnt vmcnt(16)
    ds_read_b64_tr_b16 v[40:41], v17 offset:29696
    ds_read_b64_tr_b16 v[42:43], v17 offset:30208
    ds_read_b64_tr_b16 v[44:45], v18 offset:29696
    ds_read_b64_tr_b16 v[46:47], v18 offset:30208
    ds_read_b128 v[56:59], v22
    s_waitcnt lgkmcnt(5)
    v_mfma_f32_32x32x16_bf16 v[64:79], v[48:51], v[60:63], v[64:79]
    v_mfma_f32_32x32x16_bf16 v[80:95], v[52:55], v[60:63], v[80:95]
    s_add_u32 s72, s72, 16384
    s_and_b32 s72, s72, 0x1c000
    s_add_u32 m0, s69, 27648
    s_nop 0
    buffer_load_dwordx4 v15, s[28:31], s72 offen lds
    buffer_load_dwordx4 v16, s[28:31], s72 offen offset:1024 lds
    v_xor_b32 v23, s3, v20
    s_waitcnt vmcnt(16)
    ds_read_b64_tr_b16 v[48:49], v17 offset:31744
    ds_read_b64_tr_b16 v[50:51], v17 offset:32256
    ds_read_b64_tr_b16 v[52:53], v18 offset:31744
    ds_read_b64_tr_b16 v[54:55], v18 offset:32256
    ds_read_b128 v[60:63], v23
    s_waitcnt lgkmcnt(5)
    v_mfma_f32_32x32x16_bf16 v[64:79], v[40:43], v[56:59], v[64:79]
    v_mfma_f32_32x32x16_bf16 v[80:95], v[44:47], v[56:59], v[80:95]
    s_add_u32 s76, s72, 524288
    s_add_u32 m0, s69, 29696
    s_nop 0
    buffer_load_dwordx4 v15, s[28:31], s76 offen lds
    buffer_load_dwordx4 v16, s[28:31], s76 offen offset:1024 lds
    v_xor_b32 v22, s3, v21
    s_waitcnt vmcnt(16)
    ds_read_b64_tr_b16 v[40:41], v17 offset:33792
    ds_read_b64_tr_b16 v[42:43], v17 offset:34304
    ds_read_b64_tr_b16 v[44:45], v18 offset:33792
    ds_read_b64_tr_b16 v[46:47], v18 offset:34304
    ds_read_b128 v[56:59], v22
    s_waitcnt lgkmcnt(5)
    v_mfma_f32_32x32x16_bf16 v[64:79], v[48:51], v[60:63], v[64:79]
    v_mfma_f32_32x32x16_bf16 v[80:95], v[52:55], v[60:63], v[80:95]
    s_add_u32 s73, s72, 1048576
    s_add_u32 m0, s69, 31744
    s_nop 0
    buffer_load_dwordx4 v15, s[28:31], s73 offen lds
    buffer_load_dwordx4 v16, s[28:31], s73 offen offset:1024 lds
    s_add_u32 s3, s3, 32
    s_and_b32 s3, s3, 0xe0
    v_xor_b32 v23, s3, v19
    s_waitcnt vmcnt(16)
    ds_read_b64_tr_b16 v[48:49], v17 offset:35840
    ds_read_b64_tr_b16 v[50:51], v17 offset:36352
    ds_read_b64_tr_b16 v[52:53], v18 offset:35840
    ds_read_b64_tr_b16 v[54:55], v18 offset:36352
    ds_read_b128 v[60:63], v23
    s_waitcnt lgkmcnt(5)
    v_mfma_f32_32x32x16_bf16 v[64:79], v[40:43], v[56:59], v[64:79]
    v_mfma_f32_32x32x16_bf16 v[80:95], v[44:47], v[56:59], v[80:95]
    s_add_u32 s72, s72, 16384
    s_and_b32 s72, s72, 0x1c000
    s_add_u32 m0, s69, 33792
    s_nop 0
    buffer_load_dwordx4 v15, s[28:31], s72 offen lds
    buffer_load_dwordx4 v16, s[28:31], s72 offen offset:1024 lds
    v_xor_b32 v22, s3, v20
    s_waitcnt vmcnt(16)
    ds_read_b64_tr_b16 v[40:41], v17 offset:17408
    ds_read_b64_tr_b16 v[42:43], v17 offset:17920
    ds_read_b64_tr_b16 v[44:45], v18 offset:17408
    ds_read_b64_tr_b16 v[46:47], v18 offset:17920
    ds_read_b128 v[56:59], v22
    s_waitcnt lgkmcnt(5)
    v_mfma_f32_32x32x16_bf16 v[64:79], v[48:51], v[60:63], v[64:79]
    v_mfma_f32_32x32x16_bf16 v[80:95], v[52:55], v[60:63], v[80:95]
    s_add_u32 s74, s72, 524288
    s_add_u32 m0, s69, 35840
    s_nop 0
    buffer_load_dwordx4 v15, s[28:31], s74 offen lds
    buffer_load_dwordx4 v16, s[28:31], s74 offen offset:1024 lds
    v_xor_b32 v23, s3, v21
    s_waitcnt vmcnt(16)
    ds_read_b64_tr_b16 v[48:49], v17 offset:19456
    ds_read_b64_tr_b16 v[50:51], v17 offset:19968
    ds_read_b64_tr_b16 v[52:53], v18 offset:19456
    ds_read_b64_tr_b16 v[54:55], v18 offset:19968
    ds_read_b128 v[60:63], v23
    s_waitcnt lgkmcnt(5)
    v_mfma_f32_32x32x16_bf16 v[64:79], v[40:43], v[56:59], v[64:79]
    v_mfma_f32_32x32x16_bf16 v[80:95], v[44:47], v[56:59], v[80:95]
    s_add_u32 s75, s72, 1048576
    s_add_u32 m0, s69, 17408
    s_nop 0
    buffer_load_dwordx4 v15, s[28:31], s75 offen lds
    buffer_load_dwordx4 v16, s[28:31], s75 offen offset:1024 lds
    s_add_u32 s3, s3, 32
    s_and_b32 s3, s3, 0xe0
    v_xor_b32 v22, s3, v19
    s_waitcnt vmcnt(16)
    ds_read_b64_tr_b16 v[40:41], v17 offset:21504
    ds_read_b64_tr_b16 v[42:43], v17 offset:22016
    ds_read_b64_tr_b16 v[44:45], v18 offset:21504
    ds_read_b64_tr_b16 v[46:47], v18 offset:22016
    ds_read_b128 v[56:59], v22
    s_waitcnt lgkmcnt(5)
    v_mfma_f32_32x32x16_bf16 v[64:79], v[48:51], v[60:63], v[64:79]
    v_mfma_f32_32x32x16_bf16 v[80:95], v[52:55], v[60:63], v[80:95]
    s_add_u32 s72, s72, 16384
    s_and_b32 s72, s72, 0x1c000
    s_add_u32 m0, s69, 19456
    s_nop 0
    buffer_load_dwordx4 v15, s[28:31], s72 offen lds
    buffer_load_dwordx4 v16, s[28:31], s72 offen offset:1024 lds
    v_xor_b32 v23, s3, v20
    s_waitcnt vmcnt(16)
    ds_read_b64_tr_b16 v[48:49], v17 offset:23552
    ds_read_b64_tr_b16 v[50:51], v17 offset:24064
    ds_read_b64_tr_b16 v[52:53], v18 offset:23552
    ds_read_b64_tr_b16 v[54:55], v18 offset:24064
    ds_read_b128 v[60:63], v23
    s_waitcnt lgkmcnt(5)
    v_mfma_f32_32x32x16_bf16 v[64:79], v[40:43], v[56:59], v[64:79]
    v_mfma_f32_32x32x16_bf16 v[80:95], v[44:47], v[56:59], v[80:95]
    s_add_u32 s76, s72, 524288
    s_add_u32 m0, s69, 21504
    s_nop 0
    buffer_load_dwordx4 v15, s[28:31], s76 offen lds
    buffer_load_dwordx4 v16, s[28:31], s76 offen offset:1024 lds
    v_xor_b32 v22, s3, v21
    s_waitcnt vmcnt(16)
    ds_read_b64_tr_b16 v[40:41], v17 offset:25600
    ds_read_b64_tr_b16 v[42:43], v17 offset:26112
    ds_read_b64_tr_b16 v[44:45], v18 offset:25600
    ds_read_b64_tr_b16 v[46:47], v18 offset:26112
    ds_read_b128 v[56:59], v22
    s_waitcnt lgkmcnt(5)
    v_mfma_f32_32x32x16_bf16 v[64:79], v[48:51], v[60:63], v[64:79]
    v_mfma_f32_32x32x16_bf16 v[80:95], v[52:55], v[60:63], v[80:95]
    s_add_u32 s73, s72, 1048576
    s_add_u32 m0, s69, 23552
    s_nop 0
    buffer_load_dwordx4 v15, s[28:31], s73 offen lds
    buffer_load_dwordx4 v16, s[28:31], s73 offen offset:1024 lds
    s_add_u32 s3, s3, 32
    s_and_b32 s3, s3, 0xe0
    v_xor_b32 v23, s3, v19
    s_waitcnt vmcnt(16)
    ds_read_b64_tr_b16 v[48:49], v17 offset:27648
    ds_read_b64_tr_b16 v[50:51], v17 offset:28160
    ds_read_b64_tr_b16 v[52:53], v18 offset:27648
    ds_read_b64_tr_b16 v[54:55], v18 offset:28160
    ds_read_b128 v[60:63], v23
    s_waitcnt lgkmcnt(5)
    v_mfma_f32_32x32x16_bf16 v[64:79], v[40:43], v[56:59], v[64:79]
    v_mfma_f32_32x32x16_bf16 v[80:95], v[44:47], v[56:59], v[80:95]
    v_xor_b32 v22, s3, v20
    s_waitcnt vmcnt(14)
    ds_read_b64_tr_b16 v[40:41], v17 offset:29696
    ds_read_b64_tr_b16 v[42:43], v17 offset:30208
    ds_read_b64_tr_b16 v[44:45], v18 offset:29696
    ds_read_b64_tr_b16 v[46:47], v18 offset:30208
    ds_read_b128 v[56:59], v22
    s_waitcnt lgkmcnt(5)
    v_mfma_f32_32x32x16_bf16 v[64:79], v[48:51], v[60:63], v[64:79]
    v_mfma_f32_32x32x16_bf16 v[80:95], v[52:55], v[60:63], v[80:95]
    s_lshl_b32 s74, s13, 5
    s_add_u32 m0, s69, 25600
    s_nop 0
    buffer_load_dwordx4 v24, s[32:35], s74 offen lds
    buffer_load_dwordx4 v25, s[32:35], s74 offen offset:1024 lds
    buffer_load_dwordx4 v26, s[32:35], s74 offen offset:2048 lds
    buffer_load_dwordx4 v27, s[32:35], s74 offen offset:3072 lds
    v_xor_b32 v23, s3, v21
    s_waitcnt vmcnt(16)
    ds_read_b64_tr_b16 v[48:49], v17 offset:31744
    ds_read_b64_tr_b16 v[50:51], v17 offset:32256
    ds_read_b64_tr_b16 v[52:53], v18 offset:31744
    ds_read_b64_tr_b16 v[54:55], v18 offset:32256
    ds_read_b128 v[60:63], v23
    s_waitcnt lgkmcnt(5)
    v_mfma_f32_32x32x16_bf16 v[64:79], v[40:43], v[56:59], v[64:79]
    v_mfma_f32_32x32x16_bf16 v[80:95], v[44:47], v[56:59], v[80:95]
    s_add_u32 s3, s3, 32
    s_and_b32 s3, s3, 0xe0
    v_xor_b32 v22, s3, v19
    s_waitcnt vmcnt(14)
    ds_read_b64_tr_b16 v[40:41], v17 offset:33792
    ds_read_b64_tr_b16 v[42:43], v17 offset:34304
    ds_read_b64_tr_b16 v[44:45], v18 offset:33792
    ds_read_b64_tr_b16 v[46:47], v18 offset:34304
    ds_read_b128 v[56:59], v22
    s_waitcnt lgkmcnt(5)
    v_mfma_f32_32x32x16_bf16 v[64:79], v[48:51], v[60:63], v[64:79]
    v_mfma_f32_32x32x16_bf16 v[80:95], v[52:55], v[60:63], v[80:95]
    s_lshl_b32 s75, s13, 5
    s_add_u32 s75, s75, 524288
    s_add_u32 m0, s69, 29696
    s_nop 0
    buffer_load_dwordx4 v24, s[32:35], s75 offen lds
    buffer_load_dwordx4 v25, s[32:35], s75 offen offset:1024 lds
    buffer_load_dwordx4 v26, s[32:35], s75 offen offset:2048 lds
    buffer_load_dwordx4 v27, s[32:35], s75 offen offset:3072 lds
    v_and_b32 v2, 3, v1
    v_lshlrev_b32 v2, 6, v2
    buffer_load_dword v36, v2, s[56:59], 0 offen sc1
    v_xor_b32 v23, s3, v20
    s_waitcnt vmcnt(17)
    ds_read_b64_tr_b16 v[48:49], v17 offset:35840
    ds_read_b64_tr_b16 v[50:51], v17 offset:36352
    ds_read_b64_tr_b16 v[52:53], v18 offset:35840
    ds_read_b64_tr_b16 v[54:55], v18 offset:36352
    ds_read_b128 v[60:63], v23
    s_waitcnt lgkmcnt(5)
    v_mfma_f32_32x32x16_bf16 v[64:79], v[40:43], v[56:59], v[64:79]
    v_mfma_f32_32x32x16_bf16 v[80:95], v[44:47], v[56:59], v[80:95]
    v_xor_b32 v22, s3, v21
    s_waitcnt vmcnt(15)
    ds_read_b64_tr_b16 v[40:41], v17 offset:17408
    ds_read_b64_tr_b16 v[42:43], v17 offset:17920
    ds_read_b64_tr_b16 v[44:45], v18 offset:17408
    ds_read_b64_tr_b16 v[46:47], v18 offset:17920
    ds_read_b128 v[56:59], v22
    s_waitcnt lgkmcnt(5)
    v_mfma_f32_32x32x16_bf16 v[64:79], v[48:51], v[60:63], v[64:79]
    v_mfma_f32_32x32x16_bf16 v[80:95], v[52:55], v[60:63], v[80:95]
    s_lshl_b32 s76, s13, 5
    s_add_u32 s76, s76, 1048576
    s_add_u32 m0, s69, 33792
    s_nop 0
    buffer_load_dwordx4 v24, s[32:35], s76 offen lds
    buffer_load_dwordx4 v25, s[32:35], s76 offen offset:1024 lds
    buffer_load_dwordx4 v26, s[32:35], s76 offen offset:2048 lds
    buffer_load_dwordx4 v27, s[32:35], s76 offen offset:3072 lds
    s_add_u32 s3, s3, 32
    s_and_b32 s3, s3, 0xe0
    v_xor_b32 v23, s3, v19
    s_waitcnt vmcnt(17)
    ds_read_b64_tr_b16 v[48:49], v17 offset:19456
    ds_read_b64_tr_b16 v[50:51], v17 offset:19968
    ds_read_b64_tr_b16 v[52:53], v18 offset:19456
    ds_read_b64_tr_b16 v[54:55], v18 offset:19968
    ds_read_b128 v[60:63], v23
    s_waitcnt lgkmcnt(5)
    v_mfma_f32_32x32x16_bf16 v[64:79], v[40:43], v[56:59], v[64:79]
    v_mfma_f32_32x32x16_bf16 v[80:95], v[44:47], v[56:59], v[80:95]
    v_xor_b32 v22, s3, v20
    s_waitcnt vmcnt(15)
    ds_read_b64_tr_b16 v[40:41], v17 offset:21504
    ds_read_b64_tr_b16 v[42:43], v17 offset:22016
    ds_read_b64_tr_b16 v[44:45], v18 offset:21504
    ds_read_b64_tr_b16 v[46:47], v18 offset:22016
    ds_read_b128 v[56:59], v22
    s_waitcnt lgkmcnt(5)
    v_mfma_f32_32x32x16_bf16 v[64:79], v[48:51], v[60:63], v[64:79]
    v_mfma_f32_32x32x16_bf16 v[80:95], v[52:55], v[60:63], v[80:95]
    v_xor_b32 v23, s3, v21
    s_waitcnt vmcnt(13)
    ds_read_b64_tr_b16 v[48:49], v17 offset:23552
    ds_read_b64_tr_b16 v[50:51], v17 offset:24064
    ds_read_b64_tr_b16 v[52:53], v18 offset:23552
    ds_read_b64_tr_b16 v[54:55], v18 offset:24064
    ds_read_b128 v[60:63], v23
    s_waitcnt lgkmcnt(5)
    v_mfma_f32_32x32x16_bf16 v[64:79], v[40:43], v[56:59], v[64:79]
    v_mfma_f32_32x32x16_bf16 v[80:95], v[44:47], v[56:59], v[80:95]
    s_waitcnt lgkmcnt(0)
    v_mfma_f32_32x32x16_bf16 v[64:79], v[48:51], v[60:63], v[64:79]
    v_mfma_f32_32x32x16_bf16 v[80:95], v[52:55], v[60:63], v[80:95]
    s_cmp_lg_u32 s78, 0
    s_cbranch_scc1 L_g4i_3
    s_add_u32 m0, s69, 12288
    v_and_b32 v2, 15, v1
    v_lshlrev_b32 v2, 10, v2
    v_lshrrev_b32 v3, 4, v1
    v_lshl_add_u32 v2, v3, 4, v2
    buffer_load_dwordx4 v24, s[44:47], 0 offen lds
    buffer_load_dwordx4 v25, s[44:47], 0 offen offset:1024 lds
    buffer_load_dwordx4 v26, s[44:47], 0 offen offset:2048 lds
    buffer_load_dwordx4 v27, s[44:47], 0 offen offset:3072 lds
    s_add_u32 m0, s69, 37888
    s_nop 0
    buffer_load_dwordx4 v2, s[36:39], 0 offen lds
L_g4i_3:
    v_mov_b32 v13, 0xbdd2d3e8
    v_add_u32 v5, 81920, v7
    s_nop 7
    s_nop 1
    ds_write_b128 v6, v[64:67] offset:0
    ds_write_b128 v6, v[68:71] offset:1024
    ds_write_b128 v6, v[72:75] offset:2048
    ds_write_b128 v6, v[76:79] offset:3072
    ds_write_b128 v6, v[80:83] offset:4096
    ds_write_b128 v6, v[84:87] offset:5120
    ds_write_b128 v6, v[88:91] offset:6144
    ds_write_b128 v6, v[92:95] offset:7168
    s_waitcnt lgkmcnt(0)
    s_barrier
    ds_read_b128 v[96:99], v7 offset:0
    ds_read_b128 v[100:103], v7 offset:512
    ds_read_b128 v[104:107], v7 offset:40960
    ds_read_b128 v[108:111], v7 offset:41472
    ds_read_b128 v[112:115], v5 offset:0
    ds_read_b128 v[116:119], v5 offset:512
    ds_read_b128 v[120:123], v5 offset:40960
    ds_read_b128 v[124:127], v5 offset:41472
    v_and_b32 v2, 15, v1
    v_lshlrev_b32 v2, 4, v2
    v_bfe_u32 v3, v1, 4, 1
    v_lshl_add_u32 v2, v3, 14, v2
    v_lshrrev_b32 v3, 5, v1
    v_lshl_add_u32 v2, v3, 8, v2
    s_lshl_b32 s73, s65, 15
    s_lshl_b32 s74, s66, 11
    s_add_u32 s73, s73, s74
    s_lshl_b32 s74, s64, 9
    s_add_u32 s73, s73, s74
    s_add_u32 s73, s73, 65536
    s_waitcnt lgkmcnt(4)
    v_add_f32 v96, v96, v104
    v_add_f32 v97, v97, v105
    v_add_f32 v98, v98, v106
    v_add_f32 v99, v99, v107
    v_add_f32 v100, v100, v108
    v_add_f32 v101, v101, v109
    v_add_f32 v102, v102, v110
    v_add_f32 v103, v103, v111
    s_waitcnt lgkmcnt(0)
    v_add_f32 v112, v112, v120
    v_add_f32 v113, v113, v121
    v_add_f32 v114, v114, v122
    v_add_f32 v115, v115, v123
    v_add_f32 v116, v116, v124
    v_add_f32 v117, v117, v125
    v_add_f32 v118, v118, v126
    v_add_f32 v119, v119, v127
    v_add_f32 v96, v96, v112
    v_add_f32 v97, v97, v113
    v_add_f32 v98, v98, v114
    v_add_f32 v99, v99, v115
    v_add_f32 v100, v100, v116
    v_add_f32 v101, v101, v117
    v_add_f32 v102, v102, v118
    v_add_f32 v103, v103, v119
    v_mul_f32 v104, v96, v96
    v_mul_f32 v105, v97, v97
    v_mul_f32 v106, v98, v98
    v_mul_f32 v107, v99, v99
    v_mul_f32 v108, v100, v100
    v_mul_f32 v109, v101, v101
    v_mul_f32 v110, v102, v102
    v_mul_f32 v111, v103, v103
    v_fmaak_f32 v104, v104, v13, 0xc0135761
    v_fmaak_f32 v105, v105, v13, 0xc0135761
    v_fmaak_f32 v106, v106, v13, 0xc0135761
    v_fmaak_f32 v107, v107, v13, 0xc0135761
    v_fmaak_f32 v108, v108, v13, 0xc0135761
    v_fmaak_f32 v109, v109, v13, 0xc0135761
    v_fmaak_f32 v110, v110, v13, 0xc0135761
    v_fmaak_f32 v111, v111, v13, 0xc0135761
    v_mul_f32 v104, v104, v96
    v_mul_f32 v105, v105, v97
    v_mul_f32 v106, v106, v98
    v_mul_f32 v107, v107, v99
    v_mul_f32 v108, v108, v100
    v_mul_f32 v109, v109, v101
    v_mul_f32 v110, v110, v102
    v_mul_f32 v111, v111, v103
    v_exp_f32 v104, v104
    v_exp_f32 v105, v105
    v_exp_f32 v106, v106
    v_exp_f32 v107, v107
    v_exp_f32 v108, v108
    v_exp_f32 v109, v109
    v_exp_f32 v110, v110
    v_exp_f32 v111, v111
    v_add_f32 v104, 1.0, v104
    v_add_f32 v105, 1.0, v105
    v_add_f32 v106, 1.0, v106
    v_add_f32 v107, 1.0, v107
    v_add_f32 v108, 1.0, v108
    v_add_f32 v109, 1.0, v109
    v_add_f32 v110, 1.0, v110
    v_add_f32 v111, 1.0, v111
    v_rcp_f32 v104, v104
    v_rcp_f32 v105, v105
    v_rcp_f32 v106, v106
    v_rcp_f32 v107, v107
    v_rcp_f32 v108, v108
    v_rcp_f32 v109, v109
    v_rcp_f32 v110, v110
    v_rcp_f32 v111, v111
    v_mul_f32 v96, v96, v104
    v_mul_f32 v97, v97, v105
    v_mul_f32 v98, v98, v106
    v_mul_f32 v99, v99, v107
    v_mul_f32 v100, v100, v108
    v_mul_f32 v101, v101, v109
    v_mul_f32 v102, v102, v110
    v_mul_f32 v103, v103, v111
    v_cvt_pk_bf16_f32 v112, v96, v97
    v_cvt_pk_bf16_f32 v113, v98, v99
    v_cvt_pk_bf16_f32 v114, v100, v101
    v_cvt_pk_bf16_f32 v115, v102, v103
    buffer_store_dwordx4 v[112:115], v2, s[60:63], s73 offen sc1
    s_lshl_b32 s73, s14, 5
    s_add_u32 m0, s69, 17408
    s_nop 0
    buffer_load_dwordx4 v24, s[32:35], s73 offen lds
    buffer_load_dwordx4 v25, s[32:35], s73 offen offset:1024 lds
    buffer_load_dwordx4 v26, s[32:35], s73 offen offset:2048 lds
    buffer_load_dwordx4 v27, s[32:35], s73 offen offset:3072 lds
    s_lshl_b32 s74, s14, 5
    s_add_u32 s74, s74, 524288
    s_add_u32 m0, s69, 21504
    s_nop 0
    buffer_load_dwordx4 v24, s[32:35], s74 offen lds
    buffer_load_dwordx4 v25, s[32:35], s74 offen offset:1024 lds
    buffer_load_dwordx4 v26, s[32:35], s74 offen offset:2048 lds
    buffer_load_dwordx4 v27, s[32:35], s74 offen offset:3072 lds
    s_barrier
    s_lshl_b32 s75, s14, 5
    s_add_u32 s75, s75, 1048576
    s_add_u32 m0, s69, 0
    s_nop 0
    buffer_load_dwordx4 v24, s[32:35], s75 offen lds
    buffer_load_dwordx4 v25, s[32:35], s75 offen offset:1024 lds
    buffer_load_dwordx4 v26, s[32:35], s75 offen offset:2048 lds
    buffer_load_dwordx4 v27, s[32:35], s75 offen offset:3072 lds
    s_lshl_b32 s76, s15, 5
    s_add_u32 m0, s69, 4096
    s_nop 0
    buffer_load_dwordx4 v24, s[32:35], s76 offen lds
    buffer_load_dwordx4 v25, s[32:35], s76 offen offset:1024 lds
    buffer_load_dwordx4 v26, s[32:35], s76 offen offset:2048 lds
    buffer_load_dwordx4 v27, s[32:35], s76 offen offset:3072 lds
    s_lshl_b32 s73, s15, 5
    s_add_u32 s73, s73, 524288
    s_add_u32 m0, s69, 8192
    s_nop 0
    buffer_load_dwordx4 v24, s[32:35], s73 offen lds
    buffer_load_dwordx4 v25, s[32:35], s73 offen offset:1024 lds
    buffer_load_dwordx4 v26, s[32:35], s73 offen offset:2048 lds
    buffer_load_dwordx4 v27, s[32:35], s73 offen offset:3072 lds
    s_cmp_lg_u32 s78, 0
    s_cbranch_scc1 L_g4p_4
    v_subrev_u32 v2, s69, v28
    s_lshl_b32 s73, s64, 5
    v_xor_b32 v2, s73, v2
    v_add_u32 v3, 81920, v2
    v_lshlrev_b32 v4, 4, v1
    v_add_u32 v4, 37888, v4
    v_add_u32 v5, 81920, v4
    s_waitcnt vmcnt(21) lgkmcnt(0)
    s_barrier
    ds_read_b64_tr_b16 v[128:129], v2 offset:12288
    ds_read_b64_tr_b16 v[130:131], v2 offset:12800
    ds_read_b128 v[144:147], v4 offset:0
    ds_read_b64_tr_b16 v[132:133], v2 offset:53248
    ds_read_b64_tr_b16 v[134:135], v2 offset:53760
    ds_read_b128 v[148:151], v4 offset:40960
    ds_read_b64_tr_b16 v[136:137], v3 offset:12288
    ds_read_b64_tr_b16 v[138:139], v3 offset:12800
    ds_read_b128 v[152:155], v5 offset:0
    ds_read_b64_tr_b16 v[140:141], v3 offset:53248
    ds_read_b64_tr_b16 v[142:143], v3 offset:53760
    ds_read_b128 v[156:159], v5 offset:40960
    s_and_b32 s73, s79, 7
    s_lshl_b32 s73, s73, 14
    s_lshr_b32 s74, s79, 3
    s_lshl_b32 s74, s74, 12
    s_add_u32 s73, s73, s74
    s_lshl_b32 s74, s64, 10
    s_add_u32 s73, s73, s74
    s_add_u32 s73, s73, 2752512
    s_waitcnt lgkmcnt(0)
    s_barrier
    v_lshlrev_b32 v2, 4, v1
    v_mfma_f32_16x16x32_bf16 v[160:163], v[128:131], v[144:147], 0
    v_mfma_f32_16x16x32_bf16 v[160:163], v[132:135], v[148:151], v[160:163]
    v_mfma_f32_16x16x32_bf16 v[160:163], v[136:139], v[152:155], v[160:163]
    v_mfma_f32_16x16x32_bf16 v[160:163], v[140:143], v[156:159], v[160:163]
    s_nop 7
    s_nop 3
    buffer_store_dwordx4 v[160:163], v2, s[60:63], s73 offen sc1
L_g4p_4:
    s_lshl_b32 s74, s15, 5
    s_add_u32 s74, s74, 1048576
    s_add_u32 m0, s69, 12288
    s_nop 0
    buffer_load_dwordx4 v24, s[32:35], s74 offen lds
    buffer_load_dwordx4 v25, s[32:35], s74 offen offset:1024 lds
    buffer_load_dwordx4 v26, s[32:35], s74 offen offset:2048 lds
    buffer_load_dwordx4 v27, s[32:35], s74 offen offset:3072 lds
    v_lshlrev_b32 v8, 4, v1
    v_and_b32 v2, 15, v1
    v_lshrrev_b32 v3, 4, v1
    v_add_u32 v9, 32752, v8
    v_lshlrev_b32 v4, 8, v3
    v_add_u32 v4, 240, v4
    s_cmp_eq_u32 s68, 0
    s_cselect_b32 s73, 2147483648, 0
    v_add_u32 v4, s73, v4
    v_cmp_eq_u32 vcc, 0, v2
    v_and_b32 v5, 7, v1
    v_lshlrev_b32 v5, 9, v5
    v_cndmask_b32 v9, v9, v4, vcc
    v_add_u32 v19, 508, v5
    v_add_u32 v10, 16384, v19
    v_add_u32 v4, 32768, v10
    v_add_u32 v5, s73, v10
    v_cmp_gt_u32 vcc, 8, v1
    v_bfrev_b32 v14, 1
    s_nop 0
    v_cndmask_b32 v10, v5, v4, vcc
    v_cndmask_b32 v19, v14, v19, vcc
    v_cmp_gt_u32 vcc, 16, v1
    v_lshrrev_b32 v4, 1, v3
    v_lshlrev_b32 v4, 8, v4
    v_cndmask_b32 v10, v14, v10, vcc
    v_lshl_add_u32 v4, v2, 4, v4
    v_and_b32 v3, 1, v3
    v_lshl_add_u32 v11, v3, 3, v4
    s_lshl_b32 s73, s64, 10
    v_add_u32 v12, s73, v8
    s_lshl_b32 s73, s65, 15
    s_lshl_b32 s74, s64, 12
    s_add_u32 s4, s73, s74
    s_add_u32 s4, s4, 65536
    s_sub_u32 s10, s4, 32768
    s_lshl_b32 s73, s65, 14
    s_add_u32 s5, s73, s74
    s_add_u32 s5, s5, 1114112
    s_lshl_b32 s74, s64, 9
    s_add_u32 s73, s73, s74
    s_xor_b32 s74, s66, 1
    s_lshl_b32 s74, s74, 11
    s_add_u32 s6, s73, s74
    s_add_u32 s6, s6, 1114112
    s_xor_b32 s74, s66, 2
    s_lshl_b32 s74, s74, 11
    s_add_u32 s18, s73, s74
    s_lshl_b32 s18, s18, 1
    s_add_u32 s18, s18, 1638400
    v_bfrev_b32 v20, 1
    s_lshl_b32 s19, s70, 16
    s_sub_u32 s19, s19, 16384
    v_lshrrev_b32 v2, 5, v1
    v_lshlrev_b32 v2, 9, v2
    v_bfe_u32 v3, v1, 2, 2
    v_lshl_add_u32 v2, v3, 7, v2
    v_bfe_u32 v3, v1, 4, 1
    v_lshl_add_u32 v2, v3, 6, v2
    v_and_b32 v3, 3, v1
    v_lshl_add_u32 v19, v3, 4, v2
    s_or_b32 s73, s78, s64
    s_cmp_eq_u32 s73, 0
    s_cselect_b32 s75, 0, 2147483648
    s_and_b32 s73, s79, 7
    s_lshr_b32 s74, s79, 3
    s_lshl_b32 s76, s73, 14
    s_add_u32 s76, s76, s75
    s_lshl_b32 s11, s74, 10
    s_add_u32 s76, s76, s11
    s_add_u32 s76, s76, 2752512
    v_add_u32 v21, s76, v8
    v_bfe_u32 v2, v1, 3, 1
    v_lshlrev_b32 v2, 14, v2
    v_and_b32 v3, 7, v1
    v_lshl_add_u32 v2, v3, 4, v2
    v_lshrrev_b32 v3, 5, v1
    v_lshl_add_u32 v2, v3, 8, v2
    v_bfe_u32 v3, v1, 4, 1
    v_lshl_add_u32 v2, v3, 7, v2
    s_lshl_b32 s73, s73, 11
    s_lshl_b32 s74, s74, 9
    s_add_u32 s73, s73, s74
    s_add_u32 s73, s73, s75
    s_add_u32 s73, s73, 2686976
    v_add_u32 v20, s73, v2
    s_waitcnt vmcnt(34)
    ds_read_b64_tr_b16 a[0:1], v28 offset:25600
    ds_read_b64_tr_b16 a[2:3], v28 offset:26112
    ds_read_b64_tr_b16 a[4:5], v29 offset:25600
    ds_read_b64_tr_b16 a[6:7], v29 offset:26112
    ds_read_b64_tr_b16 a[8:9], v30 offset:25600
    ds_read_b64_tr_b16 a[10:11], v30 offset:26112
    ds_read_b64_tr_b16 a[12:13], v31 offset:25600
    ds_read_b64_tr_b16 a[14:15], v31 offset:26112
    s_waitcnt vmcnt(30)
    ds_read_b64_tr_b16 a[16:17], v28 offset:29696
    ds_read_b64_tr_b16 a[18:19], v28 offset:30208
    ds_read_b64_tr_b16 a[20:21], v29 offset:29696
    ds_read_b64_tr_b16 a[22:23], v29 offset:30208
    ds_read_b64_tr_b16 a[24:25], v30 offset:29696
    ds_read_b64_tr_b16 a[26:27], v30 offset:30208
    ds_read_b64_tr_b16 a[28:29], v31 offset:29696
    ds_read_b64_tr_b16 a[30:31], v31 offset:30208
    s_waitcnt vmcnt(25)
    ds_read_b64_tr_b16 a[32:33], v28 offset:33792
    ds_read_b64_tr_b16 a[34:35], v28 offset:34304
    ds_read_b64_tr_b16 a[36:37], v29 offset:33792
    ds_read_b64_tr_b16 a[38:39], v29 offset:34304
    ds_read_b64_tr_b16 a[40:41], v30 offset:33792
    ds_read_b64_tr_b16 a[42:43], v30 offset:34304
    ds_read_b64_tr_b16 a[44:45], v31 offset:33792
    ds_read_b64_tr_b16 a[46:47], v31 offset:34304
    s_waitcnt lgkmcnt(15)
    s_lshl_b32 s75, s16, 5
    s_add_u32 m0, s69, 25600
    s_nop 0
    buffer_load_dwordx4 v24, s[32:35], s75 offen lds
    buffer_load_dwordx4 v25, s[32:35], s75 offen offset:1024 lds
    buffer_load_dwordx4 v26, s[32:35], s75 offen offset:2048 lds
    buffer_load_dwordx4 v27, s[32:35], s75 offen offset:3072 lds
    s_waitcnt lgkmcnt(8)
    s_lshl_b32 s76, s16, 5
    s_add_u32 s76, s76, 524288
    s_add_u32 m0, s69, 29696
    s_nop 0
    buffer_load_dwordx4 v24, s[32:35], s76 offen lds
    buffer_load_dwordx4 v25, s[32:35], s76 offen offset:1024 lds
    buffer_load_dwordx4 v26, s[32:35], s76 offen offset:2048 lds
    buffer_load_dwordx4 v27, s[32:35], s76 offen offset:3072 lds
    s_waitcnt lgkmcnt(0)
    s_lshl_b32 s73, s16, 5
    s_add_u32 s73, s73, 1048576
    s_add_u32 m0, s69, 33792
    s_nop 0
    buffer_load_dwordx4 v24, s[32:35], s73 offen lds
    buffer_load_dwordx4 v25, s[32:35], s73 offen offset:1024 lds
    buffer_load_dwordx4 v26, s[32:35], s73 offen offset:2048 lds
    buffer_load_dwordx4 v27, s[32:35], s73 offen offset:3072 lds
    v_cmp_gt_u32 vcc, 64, v36
    s_cbranch_vccnz L_hsw_5
L_hsd_6:
    s_waitcnt vmcnt(32)
    ds_read_b64_tr_b16 a[48:49], v28 offset:17408
    ds_read_b64_tr_b16 a[50:51], v28 offset:17920
    ds_read_b64_tr_b16 a[52:53], v29 offset:17408
    ds_read_b64_tr_b16 a[54:55], v29 offset:17920
    ds_read_b64_tr_b16 a[56:57], v30 offset:17408
    ds_read_b64_tr_b16 a[58:59], v30 offset:17920
    ds_read_b64_tr_b16 a[60:61], v31 offset:17408
    ds_read_b64_tr_b16 a[62:63], v31 offset:17920
    s_waitcnt vmcnt(28)
    ds_read_b64_tr_b16 a[64:65], v28 offset:21504
    ds_read_b64_tr_b16 a[66:67], v28 offset:22016
    ds_read_b64_tr_b16 a[68:69], v29 offset:21504
    ds_read_b64_tr_b16 a[70:71], v29 offset:22016
    ds_read_b64_tr_b16 a[72:73], v30 offset:21504
    ds_read_b64_tr_b16 a[74:75], v30 offset:22016
    ds_read_b64_tr_b16 a[76:77], v31 offset:21504
    ds_read_b64_tr_b16 a[78:79], v31 offset:22016
    s_waitcnt vmcnt(24)
    ds_read_b64_tr_b16 a[80:81], v28 offset:0
    ds_read_b64_tr_b16 a[82:83], v28 offset:512
    ds_read_b64_tr_b16 a[84:85], v29 offset:0
    ds_read_b64_tr_b16 a[86:87], v29 offset:512
    ds_read_b64_tr_b16 a[88:89], v30 offset:0
    ds_read_b64_tr_b16 a[90:91], v30 offset:512
    ds_read_b64_tr_b16 a[92:93], v31 offset:0
    ds_read_b64_tr_b16 a[94:95], v31 offset:512
    s_add_u32 s74, s4, s13
    s_sub_u32 s74, s74, 16384
    buffer_load_dwordx4 v[128:131], v9, s[60:63], s74 offen
    s_add_u32 s75, s4, s13
    buffer_load_dwordx4 v[132:135], v8, s[60:63], s75 offen
    s_add_u32 s76, s4, s13
    s_add_u32 s76, s76, 16384
    buffer_load_dwordx4 v[136:139], v8, s[60:63], s76 offen
    s_add_u32 s73, s4, s14
    s_sub_u32 s73, s73, 16384
    buffer_load_dwordx4 v[140:143], v9, s[60:63], s73 offen
    s_add_u32 s74, s4, s14
    buffer_load_dwordx4 v[144:147], v8, s[60:63], s74 offen
    s_add_u32 s75, s4, s14
    s_add_u32 s75, s75, 16384
    buffer_load_dwordx4 v[148:151], v8, s[60:63], s75 offen
    s_add_u32 s76, s4, s15
    s_sub_u32 s76, s76, 16384
    buffer_load_dwordx4 v[152:155], v9, s[60:63], s76 offen
    s_add_u32 s73, s4, s15
    buffer_load_dwordx4 v[156:159], v8, s[60:63], s73 offen
    s_add_u32 s74, s4, s15
    s_add_u32 s74, s74, 16384
    buffer_load_dwordx4 v[160:163], v8, s[60:63], s74 offen
    s_add_u32 s75, s4, s16
    s_sub_u32 s75, s75, 16384
    buffer_load_dwordx4 v[164:167], v9, s[60:63], s75 offen
    s_add_u32 s76, s4, s16
    buffer_load_dwordx4 v[168:171], v8, s[60:63], s76 offen
    s_add_u32 s73, s4, s16
    s_add_u32 s73, s73, 16384
    buffer_load_dwordx4 v[172:175], v8, s[60:63], s73 offen
    s_lshl_b32 s74, s65, 14
    s_lshl_b32 s75, s64, 9
    s_add_u32 s74, s74, s75
    s_xor_b32 s75, s66, 2
    s_lshl_b32 s75, s75, 11
    s_add_u32 s74, s74, s75
    s_lshl_b32 s74, s74, 1
    s_add_u32 s74, s74, 1638400
    v_lshlrev_b32 v38, 4, v1
    buffer_store_dwordx4 v[32:35], v38, s[60:63], s74 offen sc1
    s_waitcnt vmcnt(33)
    ds_read_b64_tr_b16 a[96:97], v28 offset:4096
    ds_read_b64_tr_b16 a[98:99], v28 offset:4608
    ds_read_b64_tr_b16 a[100:101], v29 offset:4096
    ds_read_b64_tr_b16 a[102:103], v29 offset:4608
    ds_read_b64_tr_b16 a[104:105], v30 offset:4096
    ds_read_b64_tr_b16 a[106:107], v30 offset:4608
    ds_read_b64_tr_b16 a[108:109], v31 offset:4096
    ds_read_b64_tr_b16 a[110:111], v31 offset:4608
    s_waitcnt vmcnt(29)
    ds_read_b64_tr_b16 a[112:113], v28 offset:8192
    ds_read_b64_tr_b16 a[114:115], v28 offset:8704
    ds_read_b64_tr_b16 a[116:117], v29 offset:8192
    ds_read_b64_tr_b16 a[118:119], v29 offset:8704
    ds_read_b64_tr_b16 a[120:121], v30 offset:8192
    ds_read_b64_tr_b16 a[122:123], v30 offset:8704
    ds_read_b64_tr_b16 a[124:125], v31 offset:8192
    ds_read_b64_tr_b16 a[126:127], v31 offset:8704
    s_waitcnt vmcnt(25)
    ds_read_b64_tr_b16 a[128:129], v28 offset:12288
    ds_read_b64_tr_b16 a[130:131], v28 offset:12800
    ds_read_b64_tr_b16 a[132:133], v29 offset:12288
    ds_read_b64_tr_b16 a[134:135], v29 offset:12800
    ds_read_b64_tr_b16 a[136:137], v30 offset:12288
    ds_read_b64_tr_b16 a[138:139], v30 offset:12800
    ds_read_b64_tr_b16 a[140:141], v31 offset:12288
    ds_read_b64_tr_b16 a[142:143], v31 offset:12800
    s_waitcnt vmcnt(21)
    ds_read_b64_tr_b16 a[144:145], v28 offset:25600
    ds_read_b64_tr_b16 a[146:147], v28 offset:26112
    ds_read_b64_tr_b16 a[148:149], v29 offset:25600
    ds_read_b64_tr_b16 a[150:151], v29 offset:26112
    ds_read_b64_tr_b16 a[152:153], v30 offset:25600
    ds_read_b64_tr_b16 a[154:155], v30 offset:26112
    ds_read_b64_tr_b16 a[156:157], v31 offset:25600
    ds_read_b64_tr_b16 a[158:159], v31 offset:26112
    s_waitcnt vmcnt(17)
    ds_read_b64_tr_b16 a[160:161], v28 offset:29696
    ds_read_b64_tr_b16 a[162:163], v28 offset:30208
    ds_read_b64_tr_b16 a[164:165], v29 offset:29696
    ds_read_b64_tr_b16 a[166:167], v29 offset:30208
    ds_read_b64_tr_b16 a[168:169], v30 offset:29696
    ds_read_b64_tr_b16 a[170:171], v30 offset:30208
    ds_read_b64_tr_b16 a[172:173], v31 offset:29696
    ds_read_b64_tr_b16 a[174:175], v31 offset:30208
    s_waitcnt vmcnt(13)
    ds_read_b64_tr_b16 a[176:177], v28 offset:33792
    ds_read_b64_tr_b16 a[178:179], v28 offset:34304
    ds_read_b64_tr_b16 a[180:181], v29 offset:33792
    ds_read_b64_tr_b16 a[182:183], v29 offset:34304
    ds_read_b64_tr_b16 a[184:185], v30 offset:33792
    ds_read_b64_tr_b16 a[186:187], v30 offset:34304
    ds_read_b64_tr_b16 a[188:189], v31 offset:33792
    ds_read_b64_tr_b16 a[190:191], v31 offset:34304
    s_mov_b32 s77, 0
    s_waitcnt lgkmcnt(0)
    s_lshl_b32 s76, s13, 5
    s_add_u32 m0, s69, 17408
    s_nop 0
    buffer_load_dwordx4 v24, s[40:43], s76 offen lds
    buffer_load_dwordx4 v25, s[40:43], s76 offen offset:1024 lds
    buffer_load_dwordx4 v26, s[40:43], s76 offen offset:2048 lds
    buffer_load_dwordx4 v27, s[40:43], s76 offen offset:3072 lds
L_s2m_7:
    s_waitcnt vmcnt(16)
    v_mov_b32 v2, v131
    v_mfma_f32_16x16x32_bf16 v[176:179], a[0:3], v[128:131], 0
    v_mfma_f32_16x16x32_bf16 v[180:183], a[4:7], v[128:131], 0
    v_mfma_f32_16x16x32_bf16 v[184:187], a[8:11], v[128:131], 0
    v_mfma_f32_16x16x32_bf16 v[188:191], a[12:15], v[128:131], 0
    s_lshl_b32 s73, s14, 5
    s_add_u32 m0, s69, 21504
    s_nop 0
    buffer_load_dwordx4 v24, s[40:43], s73 offen lds
    s_waitcnt vmcnt(16)
    v_mfma_f32_16x16x32_bf16 v[176:179], a[16:19], v[132:135], v[176:179]
    v_mfma_f32_16x16x32_bf16 v[180:183], a[20:23], v[132:135], v[180:183]
    v_mfma_f32_16x16x32_bf16 v[184:187], a[24:27], v[132:135], v[184:187]
    v_mfma_f32_16x16x32_bf16 v[188:191], a[28:31], v[132:135], v[188:191]
    buffer_load_dwordx4 v25, s[40:43], s73 offen offset:1024 lds
    s_waitcnt vmcnt(16)
    v_max3_u32 v2, v2, v135, v139
    v_mfma_f32_16x16x32_bf16 v[176:179], a[32:35], v[136:139], v[176:179]
    v_mfma_f32_16x16x32_bf16 v[180:183], a[36:39], v[136:139], v[180:183]
    v_mfma_f32_16x16x32_bf16 v[184:187], a[40:43], v[136:139], v[184:187]
    v_mfma_f32_16x16x32_bf16 v[188:191], a[44:47], v[136:139], v[188:191]
    buffer_load_dwordx4 v26, s[40:43], s73 offen offset:2048 lds
    s_waitcnt vmcnt(16)
    v_mfma_f32_16x16x32_bf16 v[176:179], a[48:51], v[140:143], v[176:179]
    v_mfma_f32_16x16x32_bf16 v[180:183], a[52:55], v[140:143], v[180:183]
    v_mfma_f32_16x16x32_bf16 v[184:187], a[56:59], v[140:143], v[184:187]
    v_mfma_f32_16x16x32_bf16 v[188:191], a[60:63], v[140:143], v[188:191]
    buffer_load_dwordx4 v27, s[40:43], s73 offen offset:3072 lds
    s_waitcnt vmcnt(16)
    v_max3_u32 v2, v2, v143, v147
    v_mfma_f32_16x16x32_bf16 v[176:179], a[64:67], v[144:147], v[176:179]
    v_mfma_f32_16x16x32_bf16 v[180:183], a[68:71], v[144:147], v[180:183]
    v_mfma_f32_16x16x32_bf16 v[184:187], a[72:75], v[144:147], v[184:187]
    v_mfma_f32_16x16x32_bf16 v[188:191], a[76:79], v[144:147], v[188:191]
    s_lshl_b32 s74, s15, 5
    s_add_u32 m0, s69, 25600
    s_nop 0
    buffer_load_dwordx4 v24, s[40:43], s74 offen lds
    s_waitcnt vmcnt(16)
    v_mfma_f32_16x16x32_bf16 v[176:179], a[80:83], v[148:151], v[176:179]
    v_mfma_f32_16x16x32_bf16 v[180:183], a[84:87], v[148:151], v[180:183]
    v_mfma_f32_16x16x32_bf16 v[184:187], a[88:91], v[148:151], v[184:187]
    v_mfma_f32_16x16x32_bf16 v[188:191], a[92:95], v[148:151], v[188:191]
    buffer_load_dwordx4 v25, s[40:43], s74 offen offset:1024 lds
    s_waitcnt vmcnt(16)
    v_max3_u32 v2, v2, v151, v155
    v_mfma_f32_16x16x32_bf16 v[176:179], a[96:99], v[152:155], v[176:179]
    v_mfma_f32_16x16x32_bf16 v[180:183], a[100:103], v[152:155], v[180:183]
    v_mfma_f32_16x16x32_bf16 v[184:187], a[104:107], v[152:155], v[184:187]
    v_mfma_f32_16x16x32_bf16 v[188:191], a[108:111], v[152:155], v[188:191]
    buffer_load_dwordx4 v26, s[40:43], s74 offen offset:2048 lds
    s_waitcnt vmcnt(16)
    v_mfma_f32_16x16x32_bf16 v[176:179], a[112:115], v[156:159], v[176:179]
    v_mfma_f32_16x16x32_bf16 v[180:183], a[116:119], v[156:159], v[180:183]
    v_mfma_f32_16x16x32_bf16 v[184:187], a[120:123], v[156:159], v[184:187]
    v_mfma_f32_16x16x32_bf16 v[188:191], a[124:127], v[156:159], v[188:191]
    buffer_load_dwordx4 v27, s[40:43], s74 offen offset:3072 lds
    s_waitcnt vmcnt(16)
    v_max3_u32 v2, v2, v159, v163
    v_mfma_f32_16x16x32_bf16 v[176:179], a[128:131], v[160:163], v[176:179]
    v_mfma_f32_16x16x32_bf16 v[180:183], a[132:135], v[160:163], v[180:183]
    v_mfma_f32_16x16x32_bf16 v[184:187], a[136:139], v[160:163], v[184:187]
    v_mfma_f32_16x16x32_bf16 v[188:191], a[140:143], v[160:163], v[188:191]
    s_lshl_b32 s75, s16, 5
    s_add_u32 m0, s69, 29696
    s_nop 0
    buffer_load_dwordx4 v24, s[40:43], s75 offen lds
    s_waitcnt vmcnt(16)
    v_mfma_f32_16x16x32_bf16 v[176:179], a[144:147], v[164:167], v[176:179]
    v_mfma_f32_16x16x32_bf16 v[180:183], a[148:151], v[164:167], v[180:183]
    v_mfma_f32_16x16x32_bf16 v[184:187], a[152:155], v[164:167], v[184:187]
    v_mfma_f32_16x16x32_bf16 v[188:191], a[156:159], v[164:167], v[188:191]
    buffer_load_dwordx4 v25, s[40:43], s75 offen offset:1024 lds
    s_waitcnt vmcnt(16)
    v_max3_u32 v2, v2, v167, v171
    v_mfma_f32_16x16x32_bf16 v[176:179], a[160:163], v[168:171], v[176:179]
    v_mfma_f32_16x16x32_bf16 v[180:183], a[164:167], v[168:171], v[180:183]
    v_mfma_f32_16x16x32_bf16 v[184:187], a[168:171], v[168:171], v[184:187]
    v_mfma_f32_16x16x32_bf16 v[188:191], a[172:175], v[168:171], v[188:191]
    buffer_load_dwordx4 v26, s[40:43], s75 offen offset:2048 lds
    s_waitcnt vmcnt(16)
    v_mfma_f32_16x16x32_bf16 v[176:179], a[176:179], v[172:175], v[176:179]
    v_mfma_f32_16x16x32_bf16 v[180:183], a[180:183], v[172:175], v[180:183]
    v_mfma_f32_16x16x32_bf16 v[184:187], a[184:187], v[172:175], v[184:187]
    v_mfma_f32_16x16x32_bf16 v[188:191], a[188:191], v[172:175], v[188:191]
    buffer_load_dwordx4 v27, s[40:43], s75 offen offset:3072 lds
    v_max_u32 v2, v2, v175
    v_cmp_eq_u32 vcc, -1, v2
    s_cbranch_vccnz L_s2r_8
L_s2k_9:
    s_mov_b32 s76, 0
    buffer_load_dwordx4 v[160:163], v21, s[60:63], s76 offen sc1
    s_mov_b32 s73, 4096
    buffer_load_dwordx4 v[164:167], v21, s[60:63], s73 offen sc1
    s_mov_b32 s74, 8192
    buffer_load_dwordx4 v[168:171], v21, s[60:63], s74 offen sc1
    s_mov_b32 s75, 12288
    buffer_load_dwordx4 v[172:175], v21, s[60:63], s75 offen sc1
    v_add_u32 v5, 81920, v12
    s_nop 7
    ds_write_b128 v6, v[176:179] offset:0
    ds_write_b128 v6, v[180:183] offset:1024
    ds_write_b128 v6, v[184:187] offset:2048
    ds_write_b128 v6, v[188:191] offset:3072
    s_waitcnt vmcnt(20)
    s_waitcnt lgkmcnt(0)
    s_barrier
    ds_read_b128 v[192:195], v12 offset:0
    ds_read_b128 v[196:199], v12 offset:40960
    ds_read_b128 v[200:203], v5 offset:0
    ds_read_b128 v[204:207], v5 offset:40960
    s_waitcnt lgkmcnt(2)
    v_add_f32 v192, v192, v196
    v_add_f32 v193, v193, v197
    v_add_f32 v194, v194, v198
    v_add_f32 v195, v195, v199
    s_waitcnt lgkmcnt(0)
    v_add_f32 v200, v200, v204
    v_add_f32 v201, v201, v205
    v_add_f32 v202, v202, v206
    v_add_f32 v203, v203, v207
    v_add_f32 v192, v192, v200
    v_add_f32 v193, v193, v201
    v_add_f32 v194, v194, v202
    v_add_f32 v195, v195, v203
    v_mul_f32 v196, v192, v192
    v_mul_f32 v197, v193, v193
    v_mul_f32 v198, v194, v194
    v_mul_f32 v199, v195, v195
    v_fmaak_f32 v196, v196, v13, 0xc0135761
    v_fmaak_f32 v197, v197, v13, 0xc0135761
    v_fmaak_f32 v198, v198, v13, 0xc0135761
    v_fmaak_f32 v199, v199, v13, 0xc0135761
    v_mul_f32 v196, v196, v192
    v_mul_f32 v197, v197, v193
    v_mul_f32 v198, v198, v194
    v_mul_f32 v199, v199, v195
    v_exp_f32 v196, v196
    v_exp_f32 v197, v197
    v_exp_f32 v198, v198
    v_exp_f32 v199, v199
    v_add_f32 v196, 1.0, v196
    v_add_f32 v197, 1.0, v197
    v_add_f32 v198, 1.0, v198
    v_add_f32 v199, 1.0, v199
    v_rcp_f32 v196, v196
    v_rcp_f32 v197, v197
    v_rcp_f32 v198, v198
    v_rcp_f32 v199, v199
    v_mul_f32 v192, v192, v196
    v_mul_f32 v193, v193, v197
    v_mul_f32 v194, v194, v198
    v_mul_f32 v195, v195, v199
    v_cvt_pk_bf16_f32 v200, v192, v193
    v_cvt_pk_bf16_f32 v201, v194, v195
    buffer_store_dwordx2 v[200:201], v11, s[60:63], s6 offen sc1
    s_barrier
    s_add_u32 s19, s19, 16384
    s_and_b32 s19, s19, 0x7c000
    s_add_u32 m0, s69, 33792
    s_nop 0
    buffer_load_dwordx4 v15, s[48:51], s19 offen lds
    buffer_load_dwordx4 v16, s[48:51], s19 offen offset:1024 lds
    s_add_u32 s19, s19, 16384
    s_and_b32 s19, s19, 0x7c000
    s_add_u32 m0, s69, 35840
    s_nop 0
    buffer_load_dwordx4 v15, s[48:51], s19 offen lds
    buffer_load_dwordx4 v16, s[48:51], s19 offen offset:1024 lds
    s_add_u32 s19, s19, 16384
    s_and_b32 s19, s19, 0x7c000
    s_add_u32 m0, s69, 4096
    s_nop 0
    buffer_load_dwordx4 v15, s[48:51], s19 offen lds
    buffer_load_dwordx4 v16, s[48:51], s19 offen offset:1024 lds
    s_add_u32 s19, s19, 16384
    s_and_b32 s19, s19, 0x7c000
    s_add_u32 m0, s69, 6144
    s_nop 0
    buffer_load_dwordx4 v15, s[48:51], s19 offen lds
    buffer_load_dwordx4 v16, s[48:51], s19 offen offset:1024 lds
    s_add_u32 s19, s19, 16384
    s_and_b32 s19, s19, 0x7c000
    s_add_u32 m0, s69, 8192
    s_nop 0
    buffer_load_dwordx4 v15, s[48:51], s19 offen lds
    buffer_load_dwordx4 v16, s[48:51], s19 offen offset:1024 lds
    s_add_u32 s19, s19, 16384
    s_and_b32 s19, s19, 0x7c000
    s_add_u32 m0, s69, 10240
    s_nop 0
    buffer_load_dwordx4 v15, s[48:51], s19 offen lds
    buffer_load_dwordx4 v16, s[48:51], s19 offen offset:1024 lds
    s_add_u32 s19, s19, 16384
    s_and_b32 s19, s19, 0x7c000
    s_add_u32 m0, s69, 12288
    s_nop 0
    buffer_load_dwordx4 v15, s[48:51], s19 offen lds
    buffer_load_dwordx4 v16, s[48:51], s19 offen offset:1024 lds
    s_add_u32 s19, s19, 16384
    s_and_b32 s19, s19, 0x7c000
    s_add_u32 m0, s69, 14336
    s_nop 0
    buffer_load_dwordx4 v15, s[48:51], s19 offen lds
    buffer_load_dwordx4 v16, s[48:51], s19 offen offset:1024 lds
    v_bfe_u32 v2, v1, 2, 2
    v_lshrrev_b32 v3, 5, v1
    v_lshl_add_u32 v3, v3, 3, v2
    v_lshlrev_b32 v3, 7, v3
    v_lshrrev_b32 v4, 1, v2
    v_lshl_add_u32 v3, v4, 6, v3
    v_bfe_u32 v4, v1, 4, 1
    v_lshl_add_u32 v3, v4, 5, v3
    v_and_b32 v4, 1, v1
    v_lshl_add_u32 v3, v4, 4, v3
    v_bfe_u32 v4, v1, 1, 1
    v_lshl_add_u32 v3, v4, 3, v3
    v_add_u32 v17, s69, v3
    v_xor_b32 v3, 64, v3
    v_add_u32 v18, s69, v3
    s_waitcnt vmcnt(21)
    ds_read_b64_tr_b16 a[192:193], v28 offset:17408
    ds_read_b64_tr_b16 a[194:195], v28 offset:17920
    ds_read_b64_tr_b16 a[196:197], v29 offset:17408
    ds_read_b64_tr_b16 a[198:199], v29 offset:17920
    ds_read_b64_tr_b16 a[200:201], v30 offset:17408
    ds_read_b64_tr_b16 a[202:203], v30 offset:17920
    ds_read_b64_tr_b16 a[204:205], v31 offset:17408
    ds_read_b64_tr_b16 a[206:207], v31 offset:17920
    ds_read_b64_tr_b16 a[208:209], v28 offset:21504
    ds_read_b64_tr_b16 a[210:211], v28 offset:22016
    ds_read_b64_tr_b16 a[212:213], v29 offset:21504
    ds_read_b64_tr_b16 a[214:215], v29 offset:22016
    ds_read_b64_tr_b16 a[216:217], v30 offset:21504
    ds_read_b64_tr_b16 a[218:219], v30 offset:22016
    ds_read_b64_tr_b16 a[220:221], v31 offset:21504
    ds_read_b64_tr_b16 a[222:223], v31 offset:22016
    ds_read_b64_tr_b16 a[224:225], v28 offset:25600
    ds_read_b64_tr_b16 a[226:227], v28 offset:26112
    ds_read_b64_tr_b16 a[228:229], v29 offset:25600
    ds_read_b64_tr_b16 a[230:231], v29 offset:26112
    ds_read_b64_tr_b16 a[232:233], v30 offset:25600
    ds_read_b64_tr_b16 a[234:235], v30 offset:26112
    ds_read_b64_tr_b16 a[236:237], v31 offset:25600
    ds_read_b64_tr_b16 a[238:239], v31 offset:26112
    ds_read_b64_tr_b16 a[240:241], v28 offset:29696
    ds_read_b64_tr_b16 a[242:243], v28 offset:30208
    ds_read_b64_tr_b16 a[244:245], v29 offset:29696
    ds_read_b64_tr_b16 a[246:247], v29 offset:30208
    ds_read_b64_tr_b16 a[248:249], v30 offset:29696
    ds_read_b64_tr_b16 a[250:251], v30 offset:30208
    ds_read_b64_tr_b16 a[252:253], v31 offset:29696
    ds_read_b64_tr_b16 a[254:255], v31 offset:30208
    s_mov_b32 s77, 0
    s_waitcnt vmcnt(17)
L_gpa_12:
    v_max_u32 v2, v160, v161
    v_max3_u32 v2, v2, v162, v163
    v_max3_u32 v2, v2, v164, v165
    v_max3_u32 v2, v2, v166, v167
    v_max3_u32 v2, v2, v168, v169
    v_max3_u32 v2, v2, v170, v171
    v_max3_u32 v2, v2, v172, v173
    v_max3_u32 v2, v2, v174, v175
    v_cmp_eq_u32 vcc, -1, v2
    s_cbranch_vccnz L_gpr_10
L_gpk_11:
    v_add_f32 v160, v160, v164
    v_add_f32 v168, v168, v172
    v_add_f32 v161, v161, v165
    v_add_f32 v169, v169, v173
    v_add_f32 v162, v162, v166
    v_add_f32 v170, v170, v174
    v_add_f32 v163, v163, v167
    v_add_f32 v171, v171, v175
    v_add_f32 v160, v160, v168
    v_add_f32 v161, v161, v169
    v_add_f32 v162, v162, v170
    v_add_f32 v163, v163, v171
    v_cvt_pk_bf16_f32 v164, v160, v161
    v_cvt_pk_bf16_f32 v165, v162, v163
    v_lshlrev_b32 v168, 16, v164
    v_and_b32 v169, 0xffff0000, v164
    v_lshlrev_b32 v170, 16, v165
    v_and_b32 v171, 0xffff0000, v165
    v_mul_f32 v172, 0x4038aa3b, v168
    v_mul_f32 v173, 0x4038aa3b, v169
    v_mul_f32 v174, 0x4038aa3b, v170
    v_mul_f32 v175, 0x4038aa3b, v171
    v_and_b32 v176, 0x7fffffff, v172
    v_and_b32 v177, 0x7fffffff, v173
    v_and_b32 v178, 0x7fffffff, v174
    v_and_b32 v179, 0x7fffffff, v175
    v_exp_f32 v172, v172
    v_exp_f32 v173, v173
    v_exp_f32 v174, v174
    v_exp_f32 v175, v175
    v_max3_u32 v176, v176, v177, v178
    v_max_u32 v176, v176, v179
    v_cmp_lt_u32 vcc, 0x42fa0000, v176
    s_cbranch_vccnz L_exf_13
L_exk_14:
    buffer_store_dwordx4 v[172:175], v20, s[60:63], 0 offen sc1
    s_waitcnt lgkmcnt(0)
    s_add_u32 s19, s19, 16384
    s_and_b32 s19, s19, 0x7c000
    s_add_u32 m0, s69, 17408
    s_nop 0
    buffer_load_dwordx4 v15, s[48:51], s19 offen lds
    buffer_load_dwordx4 v16, s[48:51], s19 offen offset:1024 lds
    s_add_u32 s19, s19, 16384
    s_and_b32 s19, s19, 0x7c000
    s_add_u32 m0, s69, 19456
    s_nop 0
    buffer_load_dwordx4 v15, s[48:51], s19 offen lds
    buffer_load_dwordx4 v16, s[48:51], s19 offen offset:1024 lds
    s_add_u32 s19, s19, 16384
    s_and_b32 s19, s19, 0x7c000
    s_add_u32 m0, s69, 21504
    s_nop 0
    buffer_load_dwordx4 v15, s[48:51], s19 offen lds
    buffer_load_dwordx4 v16, s[48:51], s19 offen offset:1024 lds
    s_add_u32 s19, s19, 16384
    s_and_b32 s19, s19, 0x7c000
    s_add_u32 m0, s69, 23552
    s_nop 0
    buffer_load_dwordx4 v15, s[48:51], s19 offen lds
    buffer_load_dwordx4 v16, s[48:51], s19 offen offset:1024 lds
    s_mov_b32 s77, 0
    s_add_u32 s76, s5, s13
    buffer_load_dwordx4 v[128:131], v8, s[60:63], s76 offen sc1
    s_add_u32 s73, s5, s14
    buffer_load_dwordx4 v[132:135], v8, s[60:63], s73 offen sc1
    s_add_u32 s74, s5, s15
    buffer_load_dwordx4 v[136:139], v8, s[60:63], s74 offen sc1
    s_add_u32 s75, s5, s16
    buffer_load_dwordx4 v[140:143], v8, s[60:63], s75 offen sc1
    s_waitcnt vmcnt(27)
    ds_read_b64_tr_b16 a[0:1], v17 offset:33792
    ds_read_b64_tr_b16 a[2:3], v17 offset:34304
    ds_read_b64_tr_b16 a[4:5], v18 offset:33792
    ds_read_b64_tr_b16 a[6:7], v18 offset:34304
    s_waitcnt vmcnt(25)
    ds_read_b64_tr_b16 a[8:9], v17 offset:35840
    ds_read_b64_tr_b16 a[10:11], v17 offset:36352
    ds_read_b64_tr_b16 a[12:13], v18 offset:35840
    ds_read_b64_tr_b16 a[14:15], v18 offset:36352
    s_waitcnt vmcnt(23)
    ds_read_b64_tr_b16 a[16:17], v17 offset:4096
    ds_read_b64_tr_b16 a[18:19], v17 offset:4608
    ds_read_b64_tr_b16 a[20:21], v18 offset:4096
    ds_read_b64_tr_b16 a[22:23], v18 offset:4608
    s_waitcnt vmcnt(21)
    ds_read_b64_tr_b16 a[24:25], v17 offset:6144
    ds_read_b64_tr_b16 a[26:27], v17 offset:6656
    ds_read_b64_tr_b16 a[28:29], v18 offset:6144
    ds_read_b64_tr_b16 a[30:31], v18 offset:6656
    s_waitcnt vmcnt(19)
    ds_read_b64_tr_b16 a[32:33], v17 offset:8192
    ds_read_b64_tr_b16 a[34:35], v17 offset:8704
    ds_read_b64_tr_b16 a[36:37], v18 offset:8192
    ds_read_b64_tr_b16 a[38:39], v18 offset:8704
    s_waitcnt vmcnt(17)
    ds_read_b64_tr_b16 a[40:41], v17 offset:10240
    ds_read_b64_tr_b16 a[42:43], v17 offset:10752
    ds_read_b64_tr_b16 a[44:45], v18 offset:10240
    ds_read_b64_tr_b16 a[46:47], v18 offset:10752
    s_waitcnt vmcnt(15)
    ds_read_b64_tr_b16 a[48:49], v17 offset:12288
    ds_read_b64_tr_b16 a[50:51], v17 offset:12800
    ds_read_b64_tr_b16 a[52:53], v18 offset:12288
    ds_read_b64_tr_b16 a[54:55], v18 offset:12800
    s_waitcnt vmcnt(13)
    ds_read_b64_tr_b16 a[56:57], v17 offset:14336
    ds_read_b64_tr_b16 a[58:59], v17 offset:14848
    ds_read_b64_tr_b16 a[60:61], v18 offset:14336
    ds_read_b64_tr_b16 a[62:63], v18 offset:14848
    s_waitcnt vmcnt(0)
L_fda_15:
    v_max_u32 v2, v129, v131
    v_max3_u32 v2, v2, v133, v135
    v_max3_u32 v2, v2, v137, v139
    v_max3_u32 v2, v2, v141, v143
    v_cmp_eq_u32 vcc, -1, v2
    s_cbranch_vccnz L_fdr_16
L_fdk_17:
    s_waitcnt lgkmcnt(0)
    s_add_u32 s19, s19, 16384
    s_and_b32 s19, s19, 0x7c000
    s_add_u32 m0, s69, 25600
    s_nop 0
    buffer_load_dwordx4 v15, s[48:51], s19 offen lds
    buffer_load_dwordx4 v16, s[48:51], s19 offen offset:1024 lds
    s_add_u32 s19, s19, 16384
    s_and_b32 s19, s19, 0x7c000
    s_add_u32 m0, s69, 27648
    s_nop 0
    buffer_load_dwordx4 v15, s[48:51], s19 offen lds
    buffer_load_dwordx4 v16, s[48:51], s19 offen offset:1024 lds
    s_add_u32 s19, s19, 16384
    s_and_b32 s19, s19, 0x7c000
    s_add_u32 m0, s69, 29696
    s_nop 0
    buffer_load_dwordx4 v15, s[48:51], s19 offen lds
    buffer_load_dwordx4 v16, s[48:51], s19 offen offset:1024 lds
    s_add_u32 s19, s19, 16384
    s_and_b32 s19, s19, 0x7c000
    s_add_u32 m0, s69, 31744
    s_nop 0
    buffer_load_dwordx4 v15, s[48:51], s19 offen lds
    buffer_load_dwordx4 v16, s[48:51], s19 offen offset:1024 lds
    v_mfma_f32_16x16x32_bf16 v[176:179], a[192:195], v[128:131], 0
    v_mfma_f32_16x16x32_bf16 v[180:183], a[196:199], v[128:131], 0
    v_mfma_f32_16x16x32_bf16 v[184:187], a[200:203], v[128:131], 0
    v_mfma_f32_16x16x32_bf16 v[188:191], a[204:207], v[128:131], 0
    v_mfma_f32_16x16x32_bf16 v[176:179], a[208:211], v[132:135], v[176:179]
    v_mfma_f32_16x16x32_bf16 v[180:183], a[212:215], v[132:135], v[180:183]
    v_mfma_f32_16x16x32_bf16 v[184:187], a[216:219], v[132:135], v[184:187]
    v_mfma_f32_16x16x32_bf16 v[188:191], a[220:223], v[132:135], v[188:191]
    v_mfma_f32_16x16x32_bf16 v[176:179], a[224:227], v[136:139], v[176:179]
    v_mfma_f32_16x16x32_bf16 v[180:183], a[228:231], v[136:139], v[180:183]
    v_mfma_f32_16x16x32_bf16 v[184:187], a[232:235], v[136:139], v[184:187]
    v_mfma_f32_16x16x32_bf16 v[188:191], a[236:239], v[136:139], v[188:191]
    v_mfma_f32_16x16x32_bf16 v[176:179], a[240:243], v[140:143], v[176:179]
    v_mfma_f32_16x16x32_bf16 v[180:183], a[244:247], v[140:143], v[180:183]
    v_mfma_f32_16x16x32_bf16 v[184:187], a[248:251], v[140:143], v[184:187]
    v_mfma_f32_16x16x32_bf16 v[188:191], a[252:255], v[140:143], v[188:191]
    v_add_u32 v5, 81920, v12
    s_nop 7
    ds_write_b128 v6, v[176:179] offset:0
    ds_write_b128 v6, v[180:183] offset:1024
    ds_write_b128 v6, v[184:187] offset:2048
    ds_write_b128 v6, v[188:191] offset:3072
    s_waitcnt lgkmcnt(0)
    s_barrier
    ds_read_b128 v[192:195], v12 offset:0
    ds_read_b128 v[196:199], v12 offset:40960
    ds_read_b128 v[200:203], v5 offset:0
    ds_read_b128 v[204:207], v5 offset:40960
    s_add_u32 s19, s19, 16384
    s_and_b32 s19, s19, 0x7c000
    s_add_u32 m0, s69, 33792
    s_nop 0
    buffer_load_dwordx4 v15, s[48:51], s19 offen lds
    buffer_load_dwordx4 v16, s[48:51], s19 offen offset:1024 lds
    s_add_u32 s19, s19, 16384
    s_and_b32 s19, s19, 0x7c000
    s_add_u32 m0, s69, 35840
    s_nop 0
    buffer_load_dwordx4 v15, s[48:51], s19 offen lds
    buffer_load_dwordx4 v16, s[48:51], s19 offen offset:1024 lds
    s_add_u32 s19, s19, 16384
    s_and_b32 s19, s19, 0x7c000
    s_add_u32 m0, s69, 4096
    s_nop 0
    buffer_load_dwordx4 v15, s[48:51], s19 offen lds
    buffer_load_dwordx4 v16, s[48:51], s19 offen offset:1024 lds
    s_add_u32 s19, s19, 16384
    s_and_b32 s19, s19, 0x7c000
    s_add_u32 m0, s69, 6144
    s_nop 0
    buffer_load_dwordx4 v15, s[48:51], s19 offen lds
    buffer_load_dwordx4 v16, s[48:51], s19 offen offset:1024 lds
    s_waitcnt lgkmcnt(2)
    v_add_f32 v192, v192, v196
    v_add_f32 v193, v193, v197
    v_add_f32 v194, v194, v198
    v_add_f32 v195, v195, v199
    s_waitcnt lgkmcnt(0)
    v_add_f32 v200, v200, v204
    v_add_f32 v201, v201, v205
    v_add_f32 v202, v202, v206
    v_add_f32 v203, v203, v207
    v_add_f32 v192, v192, v200
    v_add_f32 v193, v193, v201
    v_add_f32 v194, v194, v202
    v_add_f32 v195, v195, v203
    v_cvt_pk_bf16_f32 v196, v192, v193
    v_cvt_pk_bf16_f32 v197, v194, v195
    v_lshlrev_b32 v200, 16, v196
    v_and_b32 v201, 0xffff0000, v196
    v_lshlrev_b32 v202, 16, v197
    v_and_b32 v203, 0xffff0000, v197
    v_mul_f32 v204, 0x4038aa3b, v200
    v_mul_f32 v205, 0x4038aa3b, v201
    v_mul_f32 v206, 0x4038aa3b, v202
    v_mul_f32 v207, 0x4038aa3b, v203
    v_and_b32 v208, 0x7fffffff, v204
    v_and_b32 v209, 0x7fffffff, v205
    v_and_b32 v210, 0x7fffffff, v206
    v_and_b32 v211, 0x7fffffff, v207
    v_exp_f32 v204, v204
    v_exp_f32 v205, v205
    v_exp_f32 v206, v206
    v_exp_f32 v207, v207
    v_max3_u32 v208, v208, v209, v210
    v_max_u32 v208, v208, v211
    v_cmp_lt_u32 vcc, 0x42fa0000, v208
    s_cbranch_vccnz L_exf_18
L_exk_19:
    buffer_store_dwordx4 v[204:207], v19, s[60:63], s18 offen sc1
    s_barrier
    v_and_b32 v2, 7, v1
    v_lshlrev_b32 v2, 4, v2
    v_bfe_u32 v3, v1, 3, 1
    v_lshl_add_u32 v4, v3, 8, v2
    v_lshl_add_u32 v5, v3, 9, v2
    v_bfe_u32 v3, v1, 4, 1
    v_lshl_add_u32 v4, v3, 7, v4
    v_lshrrev_b32 v3, 5, v1
    v_lshl_add_u32 v21, v3, 7, v2
    v_add_u32 v21, s69, v21
    v_add_u32 v3, s70, v3
    v_add_u32 v2, 0, v3
    v_and_b32 v2, 7, v2
    v_lshl_add_u32 v8, v2, 11, v4
    v_add_u32 v2, 2, v3
    v_and_b32 v2, 7, v2
    v_lshl_add_u32 v12, v2, 11, v4
    v_add_u32 v2, 4, v3
    v_and_b32 v2, 7, v2
    v_lshl_add_u32 v13, v2, 11, v4
    v_add_u32 v2, 6, v3
    v_and_b32 v2, 7, v2
    v_lshl_add_u32 v14, v2, 11, v4
    s_lshl_b32 s8, s67, 14
    s_lshl_b32 s73, s64, 9
    s_add_u32 s8, s8, s73
    s_add_u32 s8, s8, 2686976
    buffer_load_dwordx4 v[160:163], v8, s[60:63], s8 offen
    buffer_load_dwordx4 v[164:167], v12, s[60:63], s8 offen
    buffer_load_dwordx4 v[168:171], v13, s[60:63], s8 offen
    buffer_load_dwordx4 v[172:175], v14, s[60:63], s8 offen
    v_lshrrev_b32 v3, 4, v1
    v_add_u32 v3, s70, v3
    v_and_b32 v2, 7, v3
    v_lshl_add_u32 v9, v2, 12, v5
    v_xor_b32 v20, 16384, v9
    v_lshrrev_b32 v3, 5, v1
    v_bfe_u32 v2, v1, 3, 2
    v_lshlrev_b32 v2, 4, v2
    v_lshl_add_u32 v22, v3, 7, v2
    v_add_u32 v22, s69, v22
    v_lshlrev_b32 v10, 4, v1
    v_add_u32 v11, 81920, v10
    s_lshl_b32 s7, s65, 15
    s_lshl_b32 s73, s64, 10
    s_add_u32 s7, s7, s73
    s_lshl_b32 s73, s71, 7
    s_add_u32 s7, s7, s73
    s_add_u32 s7, s7, 1638400
    s_add_u32 s19, s19, 16384
    s_and_b32 s19, s19, 0x7c000
    s_add_u32 m0, s69, 8192
    s_nop 0
    buffer_load_dwordx4 v15, s[48:51], s19 offen lds
    buffer_load_dwordx4 v16, s[48:51], s19 offen offset:1024 lds
    s_add_u32 s19, s19, 16384
    s_and_b32 s19, s19, 0x7c000
    s_add_u32 m0, s69, 10240
    s_nop 0
    buffer_load_dwordx4 v15, s[48:51], s19 offen lds
    buffer_load_dwordx4 v16, s[48:51], s19 offen offset:1024 lds
    s_add_u32 s19, s19, 16384
    s_and_b32 s19, s19, 0x7c000
    s_add_u32 m0, s69, 12288
    s_nop 0
    buffer_load_dwordx4 v15, s[48:51], s19 offen lds
    buffer_load_dwordx4 v16, s[48:51], s19 offen offset:1024 lds
    s_add_u32 s19, s19, 16384
    s_and_b32 s19, s19, 0x7c000
    s_add_u32 m0, s69, 14336
    s_nop 0
    buffer_load_dwordx4 v15, s[48:51], s19 offen lds
    buffer_load_dwordx4 v16, s[48:51], s19 offen offset:1024 lds
    ds_read_b64_tr_b16 a[64:65], v17 offset:17408
    ds_read_b64_tr_b16 a[66:67], v17 offset:17920
    ds_read_b64_tr_b16 a[68:69], v18 offset:17408
    ds_read_b64_tr_b16 a[70:71], v18 offset:17920
    ds_read_b64_tr_b16 a[72:73], v17 offset:19456
    ds_read_b64_tr_b16 a[74:75], v17 offset:19968
    ds_read_b64_tr_b16 a[76:77], v18 offset:19456
    ds_read_b64_tr_b16 a[78:79], v18 offset:19968
    ds_read_b64_tr_b16 a[80:81], v17 offset:21504
    ds_read_b64_tr_b16 a[82:83], v17 offset:22016
    ds_read_b64_tr_b16 a[84:85], v18 offset:21504
    ds_read_b64_tr_b16 a[86:87], v18 offset:22016
    ds_read_b64_tr_b16 a[88:89], v17 offset:23552
    ds_read_b64_tr_b16 a[90:91], v17 offset:24064
    ds_read_b64_tr_b16 a[92:93], v18 offset:23552
    ds_read_b64_tr_b16 a[94:95], v18 offset:24064
    s_waitcnt vmcnt(27)
    ds_read_b64_tr_b16 a[96:97], v17 offset:25600
    ds_read_b64_tr_b16 a[98:99], v17 offset:26112
    ds_read_b64_tr_b16 a[100:101], v18 offset:25600
    ds_read_b64_tr_b16 a[102:103], v18 offset:26112
    s_waitcnt vmcnt(25)
    ds_read_b64_tr_b16 a[104:105], v17 offset:27648
    ds_read_b64_tr_b16 a[106:107], v17 offset:28160
    ds_read_b64_tr_b16 a[108:109], v18 offset:27648
    ds_read_b64_tr_b16 a[110:111], v18 offset:28160
    s_waitcnt vmcnt(23)
    ds_read_b64_tr_b16 a[112:113], v17 offset:29696
    ds_read_b64_tr_b16 a[114:115], v17 offset:30208
    ds_read_b64_tr_b16 a[116:117], v18 offset:29696
    ds_read_b64_tr_b16 a[118:119], v18 offset:30208
    s_waitcnt vmcnt(21)
    ds_read_b64_tr_b16 a[120:121], v17 offset:31744
    ds_read_b64_tr_b16 a[122:123], v17 offset:32256
    ds_read_b64_tr_b16 a[124:125], v18 offset:31744
    ds_read_b64_tr_b16 a[126:127], v18 offset:32256
    s_waitcnt lgkmcnt(0)
    s_add_u32 s19, s19, 16384
    s_and_b32 s19, s19, 0x7c000
    s_add_u32 m0, s69, 17408
    s_nop 0
    buffer_load_dwordx4 v15, s[48:51], s19 offen lds
    buffer_load_dwordx4 v16, s[48:51], s19 offen offset:1024 lds
    s_add_u32 s19, s19, 16384
    s_and_b32 s19, s19, 0x7c000
    s_add_u32 m0, s69, 19456
    s_nop 0
    buffer_load_dwordx4 v15, s[48:51], s19 offen lds
    buffer_load_dwordx4 v16, s[48:51], s19 offen offset:1024 lds
    s_add_u32 s19, s19, 16384
    s_and_b32 s19, s19, 0x7c000
    s_add_u32 m0, s69, 21504
    s_nop 0
    buffer_load_dwordx4 v15, s[48:51], s19 offen lds
    buffer_load_dwordx4 v16, s[48:51], s19 offen offset:1024 lds
    s_add_u32 s19, s19, 16384
    s_and_b32 s19, s19, 0x7c000
    s_add_u32 m0, s69, 23552
    s_nop 0
    buffer_load_dwordx4 v15, s[48:51], s19 offen lds
    buffer_load_dwordx4 v16, s[48:51], s19 offen offset:1024 lds
    buffer_load_dwordx4 v[176:179], v9, s[60:63], s7 offen sc1
    buffer_load_dwordx4 v[180:183], v20, s[60:63], s7 offen sc1
    s_mov_b32 s77, 0
    s_mov_b32 s11, 0
    s_waitcnt vmcnt(18)
L_gea_22:
    v_max_u32 v2, v163, v167
    v_max3_u32 v2, v2, v171, v175
    v_cmp_gt_i32 vcc, 0, v2
    s_cbranch_vccnz L_ger_20
L_gek_21:
    ds_write_b128 v6, v[160:163] offset:0
    ds_write_b128 v6, v[164:167] offset:1024
    ds_write_b128 v6, v[168:171] offset:2048
    ds_write_b128 v6, v[172:175] offset:3072
    s_waitcnt lgkmcnt(0)
    ds_read_b128 v[32:35], v21 offset:0
    ds_read_b128 v[36:39], v21 offset:256
    ds_read_b128 v[40:43], v21 offset:512
    ds_read_b128 v[44:47], v21 offset:768
    ds_read_b128 v[48:51], v21 offset:1024
    ds_read_b128 v[52:55], v21 offset:1280
    ds_read_b128 v[56:59], v21 offset:1536
    ds_read_b128 v[60:63], v21 offset:1792
    ds_read_b128 v[64:67], v21 offset:2048
    ds_read_b128 v[68:71], v21 offset:2304
    ds_read_b128 v[72:75], v21 offset:2560
    ds_read_b128 v[76:79], v21 offset:2816
    ds_read_b128 v[80:83], v21 offset:3072
    ds_read_b128 v[84:87], v21 offset:3328
    ds_read_b128 v[88:91], v21 offset:3584
    ds_read_b128 v[92:95], v21 offset:3840
    ds_read_b64_tr_b16 a[128:129], v17 offset:33792
    ds_read_b64_tr_b16 a[130:131], v17 offset:34304
    ds_read_b64_tr_b16 a[132:133], v18 offset:33792
    ds_read_b64_tr_b16 a[134:135], v18 offset:34304
    ds_read_b64_tr_b16 a[136:137], v17 offset:35840
    ds_read_b64_tr_b16 a[138:139], v17 offset:36352
    ds_read_b64_tr_b16 a[140:141], v18 offset:35840
    ds_read_b64_tr_b16 a[142:143], v18 offset:36352
    ds_read_b64_tr_b16 a[144:145], v17 offset:4096
    ds_read_b64_tr_b16 a[146:147], v17 offset:4608
    ds_read_b64_tr_b16 a[148:149], v18 offset:4096
    ds_read_b64_tr_b16 a[150:151], v18 offset:4608
    ds_read_b64_tr_b16 a[152:153], v17 offset:6144
    ds_read_b64_tr_b16 a[154:155], v17 offset:6656
    ds_read_b64_tr_b16 a[156:157], v18 offset:6144
    ds_read_b64_tr_b16 a[158:159], v18 offset:6656
    s_waitcnt vmcnt(16)
    ds_read_b64_tr_b16 a[160:161], v17 offset:8192
    ds_read_b64_tr_b16 a[162:163], v17 offset:8704
    ds_read_b64_tr_b16 a[164:165], v18 offset:8192
    ds_read_b64_tr_b16 a[166:167], v18 offset:8704
    s_waitcnt vmcnt(14)
    ds_read_b64_tr_b16 a[168:169], v17 offset:10240
    ds_read_b64_tr_b16 a[170:171], v17 offset:10752
    ds_read_b64_tr_b16 a[172:173], v18 offset:10240
    ds_read_b64_tr_b16 a[174:175], v18 offset:10752
    s_waitcnt vmcnt(12)
    ds_read_b64_tr_b16 a[176:177], v17 offset:12288
    ds_read_b64_tr_b16 a[178:179], v17 offset:12800
    ds_read_b64_tr_b16 a[180:181], v18 offset:12288
    ds_read_b64_tr_b16 a[182:183], v18 offset:12800
    s_waitcnt vmcnt(10)
    ds_read_b64_tr_b16 a[184:185], v17 offset:14336
    ds_read_b64_tr_b16 a[186:187], v17 offset:14848
    ds_read_b64_tr_b16 a[188:189], v18 offset:14336
    ds_read_b64_tr_b16 a[190:191], v18 offset:14848
    s_mov_b32 s77, 0
    s_waitcnt vmcnt(0)
L_fea_25:
    v_max_u32 v2, v179, v183
    v_cmp_gt_i32 vcc, 0, v2
    s_cbranch_vccnz L_fer_23
L_fek_24:
    ds_write_b128 v6, v[176:179] offset:38912
    ds_write_b128 v6, v[180:183] offset:39936
    s_cmp_lg_u32 s11, 0
    s_cbranch_scc1 L_exs_26
L_exq_27:
    s_waitcnt lgkmcnt(0)
    ds_read_b128 v[96:99], v22 offset:38912
    ds_read_b128 v[100:103], v22 offset:38976
    ds_read_b128 v[104:107], v22 offset:39168
    ds_read_b128 v[108:111], v22 offset:39232
    ds_read_b128 v[112:115], v22 offset:39424
    ds_read_b128 v[116:119], v22 offset:39488
    ds_read_b128 v[120:123], v22 offset:39680
    ds_read_b128 v[124:127], v22 offset:39744
    s_waitcnt lgkmcnt(6)
    s_add_u32 s19, s19, 16384
    s_and_b32 s19, s19, 0x7c000
    s_add_u32 m0, s69, 25600
    s_nop 0
    buffer_load_dwordx4 v15, s[48:51], s19 offen lds
    buffer_load_dwordx4 v16, s[48:51], s19 offen offset:1024 lds
    v_fma_f32 v224, v96, v32, 1.0
    v_fma_f32 v225, v97, v33, 1.0
    v_fma_f32 v226, v98, v34, 1.0
    v_fma_f32 v227, v99, v35, 1.0
    v_fma_f32 v228, v100, v36, 1.0
    v_fma_f32 v229, v101, v37, 1.0
    v_fma_f32 v230, v102, v38, 1.0
    v_fma_f32 v231, v103, v39, 1.0
    v_rcp_f32 v224, v224
    v_rcp_f32 v225, v225
    v_rcp_f32 v226, v226
    v_rcp_f32 v227, v227
    v_rcp_f32 v228, v228
    v_rcp_f32 v229, v229
    v_rcp_f32 v230, v230
    v_rcp_f32 v231, v231
    v_fma_f32 v224, v224, -2.0, 1.0
    v_fma_f32 v225, v225, -2.0, 1.0
    v_fma_f32 v226, v226, -2.0, 1.0
    v_fma_f32 v227, v227, -2.0, 1.0
    v_fma_f32 v228, v228, -2.0, 1.0
    v_fma_f32 v229, v229, -2.0, 1.0
    v_fma_f32 v230, v230, -2.0, 1.0
    v_fma_f32 v231, v231, -2.0, 1.0
    v_cvt_pk_bf16_f32 v240, v224, v225
    v_cvt_pk_bf16_f32 v241, v226, v227
    v_cvt_pk_bf16_f32 v242, v228, v229
    v_cvt_pk_bf16_f32 v243, v230, v231
    ds_write_b128 v6, v[240:243] offset:0
    s_add_u32 s19, s19, 16384
    s_and_b32 s19, s19, 0x7c000
    s_add_u32 m0, s69, 27648
    s_nop 0
    buffer_load_dwordx4 v15, s[48:51], s19 offen lds
    buffer_load_dwordx4 v16, s[48:51], s19 offen offset:1024 lds
    s_waitcnt lgkmcnt(5)
    v_fma_f32 v232, v104, v40, 1.0
    v_fma_f32 v233, v105, v41, 1.0
    v_fma_f32 v234, v106, v42, 1.0
    v_fma_f32 v235, v107, v43, 1.0
    v_fma_f32 v236, v108, v44, 1.0
    v_fma_f32 v237, v109, v45, 1.0
    v_fma_f32 v238, v110, v46, 1.0
    v_fma_f32 v239, v111, v47, 1.0
    s_waitcnt lgkmcnt(0)
    s_barrier
    ds_read_b128 v[160:163], v10 offset:0
    ds_read_b128 v[164:167], v10 offset:40960
    ds_read_b128 v[168:171], v11 offset:0
    ds_read_b128 v[172:175], v11 offset:40960
    v_rcp_f32 v232, v232
    v_rcp_f32 v233, v233
    v_rcp_f32 v234, v234
    v_rcp_f32 v235, v235
    v_rcp_f32 v236, v236
    v_rcp_f32 v237, v237
    v_rcp_f32 v238, v238
    v_rcp_f32 v239, v239
    v_fma_f32 v232, v232, -2.0, 1.0
    v_fma_f32 v233, v233, -2.0, 1.0
    v_fma_f32 v234, v234, -2.0, 1.0
    v_fma_f32 v235, v235, -2.0, 1.0
    v_fma_f32 v236, v236, -2.0, 1.0
    v_fma_f32 v237, v237, -2.0, 1.0
    v_fma_f32 v238, v238, -2.0, 1.0
    v_fma_f32 v239, v239, -2.0, 1.0
    v_cvt_pk_bf16_f32 v244, v232, v233
    v_cvt_pk_bf16_f32 v245, v234, v235
    v_cvt_pk_bf16_f32 v246, v236, v237
    v_cvt_pk_bf16_f32 v247, v238, v239
    ds_write_b128 v6, v[244:247] offset:1024
    s_waitcnt lgkmcnt(1)
    v_mfma_f32_32x32x16_bf16 v[192:207], a[0:3], v[160:163], 0
    ds_read_b128 v[128:131], v22 offset:39936
    ds_read_b128 v[132:135], v22 offset:40000
    v_fma_f32 v224, v112, v48, 1.0
    v_fma_f32 v225, v113, v49, 1.0
    v_fma_f32 v226, v114, v50, 1.0
    v_fma_f32 v227, v115, v51, 1.0
    v_fma_f32 v228, v116, v52, 1.0
    v_mfma_f32_32x32x16_bf16 v[208:223], a[4:7], v[160:163], 0
    ds_read_b128 v[136:139], v22 offset:40192
    ds_read_b128 v[140:143], v22 offset:40256
    v_fma_f32 v229, v117, v53, 1.0
    v_fma_f32 v230, v118, v54, 1.0
    v_fma_f32 v231, v119, v55, 1.0
    v_rcp_f32 v224, v224
    v_mfma_f32_32x32x16_bf16 v[192:207], a[8:11], v[164:167], v[192:207]
    v_rcp_f32 v225, v225
    v_rcp_f32 v226, v226
    v_mfma_f32_32x32x16_bf16 v[208:223], a[12:15], v[164:167], v[208:223]
    s_add_u32 s19, s19, 16384
    s_and_b32 s19, s19, 0x7c000
    s_add_u32 m0, s69, 29696
    s_nop 0
    buffer_load_dwordx4 v15, s[48:51], s19 offen lds
    buffer_load_dwordx4 v16, s[48:51], s19 offen offset:1024 lds
    v_rcp_f32 v227, v227
    v_rcp_f32 v228, v228
    v_rcp_f32 v229, v229
    v_mfma_f32_32x32x16_bf16 v[192:207], a[16:19], v[168:171], v[192:207]
    v_rcp_f32 v230, v230
    v_rcp_f32 v231, v231
    v_mfma_f32_32x32x16_bf16 v[208:223], a[20:23], v[168:171], v[208:223]
    s_waitcnt lgkmcnt(4)
    s_barrier
    ds_read_b128 v[176:179], v10 offset:1024
    ds_read_b128 v[180:183], v10 offset:41984
    ds_read_b128 v[184:187], v11 offset:1024
    ds_read_b128 v[188:191], v11 offset:41984
    v_fma_f32 v224, v224, -2.0, 1.0
    v_fma_f32 v225, v225, -2.0, 1.0
    v_fma_f32 v226, v226, -2.0, 1.0
    v_fma_f32 v227, v227, -2.0, 1.0
    v_mfma_f32_32x32x16_bf16 v[192:207], a[24:27], v[172:175], v[192:207]
    v_fma_f32 v228, v228, -2.0, 1.0
    v_fma_f32 v229, v229, -2.0, 1.0
    v_fma_f32 v230, v230, -2.0, 1.0
    v_fma_f32 v231, v231, -2.0, 1.0
    v_cvt_pk_bf16_f32 v240, v224, v225
    v_mfma_f32_32x32x16_bf16 v[208:223], a[28:31], v[172:175], v[208:223]
    s_add_u32 s19, s19, 16384
    s_and_b32 s19, s19, 0x7c000
    s_add_u32 m0, s69, 31744
    s_nop 0
    buffer_load_dwordx4 v15, s[48:51], s19 offen lds
    buffer_load_dwordx4 v16, s[48:51], s19 offen offset:1024 lds
    v_cvt_pk_bf16_f32 v241, v226, v227
    v_cvt_pk_bf16_f32 v242, v228, v229
    v_cvt_pk_bf16_f32 v243, v230, v231
    ds_write_b128 v6, v[240:243] offset:2048
    s_waitcnt lgkmcnt(1)
    v_mfma_f32_32x32x16_bf16 v[192:207], a[32:35], v[176:179], v[192:207]
    ds_read_b128 v[144:147], v22 offset:40448
    ds_read_b128 v[148:151], v22 offset:40512
    v_fma_f32 v232, v120, v56, 1.0
    v_fma_f32 v233, v121, v57, 1.0
    v_fma_f32 v234, v122, v58, 1.0
    v_fma_f32 v235, v123, v59, 1.0
    v_fma_f32 v236, v124, v60, 1.0
    v_mfma_f32_32x32x16_bf16 v[208:223], a[36:39], v[176:179], v[208:223]
    ds_read_b128 v[152:155], v22 offset:40704
    ds_read_b128 v[156:159], v22 offset:40768
    v_fma_f32 v237, v125, v61, 1.0
    v_fma_f32 v238, v126, v62, 1.0
    v_fma_f32 v239, v127, v63, 1.0
    v_rcp_f32 v232, v232
    v_mfma_f32_32x32x16_bf16 v[192:207], a[40:43], v[180:183], v[192:207]
    v_rcp_f32 v233, v233
    v_rcp_f32 v234, v234
    v_mfma_f32_32x32x16_bf16 v[208:223], a[44:47], v[180:183], v[208:223]
    s_waitcnt lgkmcnt(4)
    s_barrier
    ds_read_b128 v[160:163], v10 offset:2048
    ds_read_b128 v[164:167], v10 offset:43008
    ds_read_b128 v[168:171], v11 offset:2048
    ds_read_b128 v[172:175], v11 offset:43008
    v_rcp_f32 v235, v235
    v_rcp_f32 v236, v236
    v_rcp_f32 v237, v237
    v_mfma_f32_32x32x16_bf16 v[192:207], a[48:51], v[184:187], v[192:207]
    v_rcp_f32 v238, v238
    v_rcp_f32 v239, v239
    v_mfma_f32_32x32x16_bf16 v[208:223], a[52:55], v[184:187], v[208:223]
    v_fma_f32 v232, v232, -2.0, 1.0
    v_fma_f32 v233, v233, -2.0, 1.0
    v_fma_f32 v234, v234, -2.0, 1.0
    v_fma_f32 v235, v235, -2.0, 1.0
    v_mfma_f32_32x32x16_bf16 v[192:207], a[56:59], v[188:191], v[192:207]
    v_fma_f32 v236, v236, -2.0, 1.0
    v_fma_f32 v237, v237, -2.0, 1.0
    v_fma_f32 v238, v238, -2.0, 1.0
    v_fma_f32 v239, v239, -2.0, 1.0
    v_cvt_pk_bf16_f32 v244, v232, v233
    v_mfma_f32_32x32x16_bf16 v[208:223], a[60:63], v[188:191], v[208:223]
    v_cvt_pk_bf16_f32 v245, v234, v235
    v_cvt_pk_bf16_f32 v246, v236, v237
    v_cvt_pk_bf16_f32 v247, v238, v239
    ds_write_b128 v6, v[244:247] offset:3072
    s_waitcnt lgkmcnt(1)
    v_mfma_f32_32x32x16_bf16 v[192:207], a[64:67], v[160:163], v[192:207]
    v_fma_f32 v224, v128, v64, 1.0
    v_fma_f32 v225, v129, v65, 1.0
    v_fma_f32 v226, v130, v66, 1.0
    v_fma_f32 v227, v131, v67, 1.0
    v_fma_f32 v228, v132, v68, 1.0
    v_mfma_f32_32x32x16_bf16 v[208:223], a[68:71], v[160:163], v[208:223]
    v_fma_f32 v229, v133, v69, 1.0
    v_fma_f32 v230, v134, v70, 1.0
    v_fma_f32 v231, v135, v71, 1.0
    v_rcp_f32 v224, v224
    v_mfma_f32_32x32x16_bf16 v[192:207], a[72:75], v[164:167], v[192:207]
    v_rcp_f32 v225, v225
    v_rcp_f32 v226, v226
    v_mfma_f32_32x32x16_bf16 v[208:223], a[76:79], v[164:167], v[208:223]
    s_waitcnt lgkmcnt(0)
    s_barrier
    ds_read_b128 v[176:179], v10 offset:3072
    ds_read_b128 v[180:183], v10 offset:44032
    ds_read_b128 v[184:187], v11 offset:3072
    ds_read_b128 v[188:191], v11 offset:44032
    v_rcp_f32 v227, v227
    v_rcp_f32 v228, v228
    v_rcp_f32 v229, v229
    v_mfma_f32_32x32x16_bf16 v[192:207], a[80:83], v[168:171], v[192:207]
    ds_read_b64_tr_b16 a[192:193], v17 offset:17408
    ds_read_b64_tr_b16 a[194:195], v17 offset:17920
    v_rcp_f32 v230, v230
    v_rcp_f32 v231, v231
    v_mfma_f32_32x32x16_bf16 v[208:223], a[84:87], v[168:171], v[208:223]
    ds_read_b64_tr_b16 a[196:197], v18 offset:17408
    ds_read_b64_tr_b16 a[198:199], v18 offset:17920
    v_fma_f32 v224, v224, -2.0, 1.0
    v_fma_f32 v225, v225, -2.0, 1.0
    v_fma_f32 v226, v226, -2.0, 1.0
    v_fma_f32 v227, v227, -2.0, 1.0
    v_mfma_f32_32x32x16_bf16 v[192:207], a[88:91], v[172:175], v[192:207]
    ds_read_b64_tr_b16 a[200:201], v17 offset:19456
    ds_read_b64_tr_b16 a[202:203], v17 offset:19968
    v_fma_f32 v228, v228, -2.0, 1.0
    v_fma_f32 v229, v229, -2.0, 1.0
    v_fma_f32 v230, v230, -2.0, 1.0
    v_fma_f32 v231, v231, -2.0, 1.0
    v_cvt_pk_bf16_f32 v240, v224, v225
    v_mfma_f32_32x32x16_bf16 v[208:223], a[92:95], v[172:175], v[208:223]
    ds_read_b64_tr_b16 a[204:205], v18 offset:19456
    ds_read_b64_tr_b16 a[206:207], v18 offset:19968
    v_cvt_pk_bf16_f32 v241, v226, v227
    v_cvt_pk_bf16_f32 v242, v228, v229
    v_cvt_pk_bf16_f32 v243, v230, v231
    ds_write_b128 v6, v[240:243] offset:4096
    s_waitcnt lgkmcnt(9)
    v_mfma_f32_32x32x16_bf16 v[192:207], a[96:99], v[176:179], v[192:207]
    v_fma_f32 v232, v136, v72, 1.0
    v_fma_f32 v233, v137, v73, 1.0
    v_fma_f32 v234, v138, v74, 1.0
    v_fma_f32 v235, v139, v75, 1.0
    v_fma_f32 v236, v140, v76, 1.0
    v_mfma_f32_32x32x16_bf16 v[208:223], a[100:103], v[176:179], v[208:223]
    v_fma_f32 v237, v141, v77, 1.0
    v_fma_f32 v238, v142, v78, 1.0
    v_fma_f32 v239, v143, v79, 1.0
    v_rcp_f32 v232, v232
    v_mfma_f32_32x32x16_bf16 v[192:207], a[104:107], v[180:183], v[192:207]
    v_rcp_f32 v233, v233
    v_rcp_f32 v234, v234
    v_mfma_f32_32x32x16_bf16 v[208:223], a[108:111], v[180:183], v[208:223]
    s_waitcnt lgkmcnt(0)
    s_barrier
    ds_read_b128 v[160:163], v10 offset:4096
    ds_read_b128 v[164:167], v10 offset:45056
    ds_read_b128 v[168:171], v11 offset:4096
    ds_read_b128 v[172:175], v11 offset:45056
    v_rcp_f32 v235, v235
    v_rcp_f32 v236, v236
    v_rcp_f32 v237, v237
    v_mfma_f32_32x32x16_bf16 v[192:207], a[112:115], v[184:187], v[192:207]
    ds_read_b64_tr_b16 a[208:209], v17 offset:21504
    ds_read_b64_tr_b16 a[210:211], v17 offset:22016
    v_rcp_f32 v238, v238
    v_rcp_f32 v239, v239
    v_mfma_f32_32x32x16_bf16 v[208:223], a[116:119], v[184:187], v[208:223]
    ds_read_b64_tr_b16 a[212:213], v18 offset:21504
    ds_read_b64_tr_b16 a[214:215], v18 offset:22016
    v_fma_f32 v232, v232, -2.0, 1.0
    v_fma_f32 v233, v233, -2.0, 1.0
    v_fma_f32 v234, v234, -2.0, 1.0
    v_fma_f32 v235, v235, -2.0, 1.0
    v_mfma_f32_32x32x16_bf16 v[192:207], a[120:123], v[188:191], v[192:207]
    ds_read_b64_tr_b16 a[216:217], v17 offset:23552
    ds_read_b64_tr_b16 a[218:219], v17 offset:24064
    v_fma_f32 v236, v236, -2.0, 1.0
    v_fma_f32 v237, v237, -2.0, 1.0
    v_fma_f32 v238, v238, -2.0, 1.0
    v_fma_f32 v239, v239, -2.0, 1.0
    v_cvt_pk_bf16_f32 v244, v232, v233
    v_mfma_f32_32x32x16_bf16 v[208:223], a[124:127], v[188:191], v[208:223]
    ds_read_b64_tr_b16 a[220:221], v18 offset:23552
    ds_read_b64_tr_b16 a[222:223], v18 offset:24064
    v_cvt_pk_bf16_f32 v245, v234, v235
    v_cvt_pk_bf16_f32 v246, v236, v237
    v_cvt_pk_bf16_f32 v247, v238, v239
    ds_write_b128 v6, v[244:247] offset:5120
    s_waitcnt lgkmcnt(9)
    v_mfma_f32_32x32x16_bf16 v[192:207], a[128:131], v[160:163], v[192:207]
    v_fma_f32 v224, v144, v80, 1.0
    v_fma_f32 v225, v145, v81, 1.0
    v_fma_f32 v226, v146, v82, 1.0
    v_fma_f32 v227, v147, v83, 1.0
    v_fma_f32 v228, v148, v84, 1.0
    v_mfma_f32_32x32x16_bf16 v[208:223], a[132:135], v[160:163], v[208:223]
    v_fma_f32 v229, v149, v85, 1.0
    v_fma_f32 v230, v150, v86, 1.0
    v_fma_f32 v231, v151, v87, 1.0
    v_rcp_f32 v224, v224
    v_mfma_f32_32x32x16_bf16 v[192:207], a[136:139], v[164:167], v[192:207]
    v_rcp_f32 v225, v225
    v_rcp_f32 v226, v226
    v_mfma_f32_32x32x16_bf16 v[208:223], a[140:143], v[164:167], v[208:223]
    s_waitcnt lgkmcnt(0)
    s_barrier
    ds_read_b128 v[176:179], v10 offset:5120
    ds_read_b128 v[180:183], v10 offset:46080
    ds_read_b128 v[184:187], v11 offset:5120
    ds_read_b128 v[188:191], v11 offset:46080
    v_rcp_f32 v227, v227
    v_rcp_f32 v228, v228
    v_rcp_f32 v229, v229
    v_mfma_f32_32x32x16_bf16 v[192:207], a[144:147], v[168:171], v[192:207]
    s_waitcnt vmcnt(6)
    ds_read_b64_tr_b16 a[224:225], v17 offset:25600
    ds_read_b64_tr_b16 a[226:227], v17 offset:26112
    v_rcp_f32 v230, v230
    v_rcp_f32 v231, v231
    v_mfma_f32_32x32x16_bf16 v[208:223], a[148:151], v[168:171], v[208:223]
    ds_read_b64_tr_b16 a[228:229], v18 offset:25600
    ds_read_b64_tr_b16 a[230:231], v18 offset:26112
    v_fma_f32 v224, v224, -2.0, 1.0
    v_fma_f32 v225, v225, -2.0, 1.0
    v_fma_f32 v226, v226, -2.0, 1.0
    v_fma_f32 v227, v227, -2.0, 1.0
    v_mfma_f32_32x32x16_bf16 v[192:207], a[152:155], v[172:175], v[192:207]
    s_waitcnt vmcnt(4)
    ds_read_b64_tr_b16 a[232:233], v17 offset:27648
    ds_read_b64_tr_b16 a[234:235], v17 offset:28160
    v_fma_f32 v228, v228, -2.0, 1.0
    v_fma_f32 v229, v229, -2.0, 1.0
    v_fma_f32 v230, v230, -2.0, 1.0
    v_fma_f32 v231, v231, -2.0, 1.0
    v_cvt_pk_bf16_f32 v240, v224, v225
    v_mfma_f32_32x32x16_bf16 v[208:223], a[156:159], v[172:175], v[208:223]
    ds_read_b64_tr_b16 a[236:237], v18 offset:27648
    ds_read_b64_tr_b16 a[238:239], v18 offset:28160
    v_cvt_pk_bf16_f32 v241, v226, v227
    v_cvt_pk_bf16_f32 v242, v228, v229
    v_cvt_pk_bf16_f32 v243, v230, v231
    ds_write_b128 v6, v[240:243] offset:6144
    s_waitcnt lgkmcnt(9)
    v_mfma_f32_32x32x16_bf16 v[192:207], a[160:163], v[176:179], v[192:207]
    v_fma_f32 v232, v152, v88, 1.0
    v_fma_f32 v233, v153, v89, 1.0
    v_fma_f32 v234, v154, v90, 1.0
    v_fma_f32 v235, v155, v91, 1.0
    v_fma_f32 v236, v156, v92, 1.0
    v_mfma_f32_32x32x16_bf16 v[208:223], a[164:167], v[176:179], v[208:223]
    v_fma_f32 v237, v157, v93, 1.0
    v_fma_f32 v238, v158, v94, 1.0
    v_fma_f32 v239, v159, v95, 1.0
    v_rcp_f32 v232, v232
    v_mfma_f32_32x32x16_bf16 v[192:207], a[168:171], v[180:183], v[192:207]
    v_rcp_f32 v233, v233
    v_rcp_f32 v234, v234
    v_mfma_f32_32x32x16_bf16 v[208:223], a[172:175], v[180:183], v[208:223]
    s_waitcnt lgkmcnt(0)
    s_barrier
    ds_read_b128 v[160:163], v10 offset:6144
    ds_read_b128 v[164:167], v10 offset:47104
    ds_read_b128 v[168:171], v11 offset:6144
    ds_read_b128 v[172:175], v11 offset:47104
    v_rcp_f32 v235, v235
    v_rcp_f32 v236, v236
    v_rcp_f32 v237, v237
    v_mfma_f32_32x32x16_bf16 v[192:207], a[176:179], v[184:187], v[192:207]
    s_waitcnt vmcnt(2)
    ds_read_b64_tr_b16 a[240:241], v17 offset:29696
    ds_read_b64_tr_b16 a[242:243], v17 offset:30208
    v_rcp_f32 v238, v238
    v_rcp_f32 v239, v239
    v_mfma_f32_32x32x16_bf16 v[208:223], a[180:183], v[184:187], v[208:223]
    ds_read_b64_tr_b16 a[244:245], v18 offset:29696
    ds_read_b64_tr_b16 a[246:247], v18 offset:30208
    v_fma_f32 v232, v232, -2.0, 1.0
    v_fma_f32 v233, v233, -2.0, 1.0
    v_fma_f32 v234, v234, -2.0, 1.0
    v_fma_f32 v235, v235, -2.0, 1.0
    v_mfma_f32_32x32x16_bf16 v[192:207], a[184:187], v[188:191], v[192:207]
    s_waitcnt vmcnt(0)
    ds_read_b64_tr_b16 a[248:249], v17 offset:31744
    ds_read_b64_tr_b16 a[250:251], v17 offset:32256
    v_fma_f32 v236, v236, -2.0, 1.0
    v_fma_f32 v237, v237, -2.0, 1.0
    v_fma_f32 v238, v238, -2.0, 1.0
    v_fma_f32 v239, v239, -2.0, 1.0
    v_cvt_pk_bf16_f32 v244, v232, v233
    v_mfma_f32_32x32x16_bf16 v[208:223], a[188:191], v[188:191], v[208:223]
    ds_read_b64_tr_b16 a[252:253], v18 offset:31744
    ds_read_b64_tr_b16 a[254:255], v18 offset:32256
    v_cvt_pk_bf16_f32 v245, v234, v235
    v_cvt_pk_bf16_f32 v246, v236, v237
    v_cvt_pk_bf16_f32 v247, v238, v239
    ds_write_b128 v6, v[244:247] offset:7168
    s_waitcnt lgkmcnt(9)
    s_waitcnt lgkmcnt(1)
    v_mfma_f32_32x32x16_bf16 v[192:207], a[192:195], v[160:163], v[192:207]
    v_mfma_f32_32x32x16_bf16 v[208:223], a[196:199], v[160:163], v[208:223]
    v_mfma_f32_32x32x16_bf16 v[192:207], a[200:203], v[164:167], v[192:207]
    v_mfma_f32_32x32x16_bf16 v[208:223], a[204:207], v[164:167], v[208:223]
    s_waitcnt lgkmcnt(0)
    s_barrier
    ds_read_b128 v[176:179], v10 offset:7168
    ds_read_b128 v[180:183], v10 offset:48128
    ds_read_b128 v[184:187], v11 offset:7168
    ds_read_b128 v[188:191], v11 offset:48128
    v_mfma_f32_32x32x16_bf16 v[192:207], a[208:211], v[168:171], v[192:207]
    v_mfma_f32_32x32x16_bf16 v[208:223], a[212:215], v[168:171], v[208:223]
    v_mfma_f32_32x32x16_bf16 v[192:207], a[216:219], v[172:175], v[192:207]
    v_mfma_f32_32x32x16_bf16 v[208:223], a[220:223], v[172:175], v[208:223]
    s_lshl_b32 s73, s68, 7
    s_lshl_b32 s74, s71, 5
    s_add_u32 s73, s73, s74
    s_lshl_b32 s73, s73, 10
    s_lshl_b32 s74, s17, 9
    s_add_u32 s73, s73, s74
    s_lshl_b32 s74, s64, 7
    s_add_u32 s11, s73, s74
    v_and_b32 v3, 31, v1
    v_lshrrev_b32 v2, 5, v1
    v_xor_b32 v2, v2, v3
    v_and_b32 v2, 7, v2
    v_lshlrev_b32 v2, 4, v2
    v_lshl_add_u32 v2, v3, 7, v2
    v_add_u32 v2, s69, v2
    v_lshrrev_b32 v3, 3, v1
    v_and_b32 v5, 7, v1
    v_xor_b32 v4, v3, v5
    v_lshlrev_b32 v4, 4, v4
    v_lshl_add_u32 v4, v3, 7, v4
    v_add_u32 v4, s69, v4
    v_lshlrev_b32 v5, 4, v5
    v_lshl_add_u32 v5, v3, 10, v5
    s_waitcnt lgkmcnt(0)
    v_mfma_f32_32x32x16_bf16 v[192:207], a[224:227], v[176:179], v[192:207]
    v_mfma_f32_32x32x16_bf16 v[208:223], a[228:231], v[176:179], v[208:223]
    v_mfma_f32_32x32x16_bf16 v[192:207], a[232:235], v[180:183], v[192:207]
    v_mfma_f32_32x32x16_bf16 v[208:223], a[236:239], v[180:183], v[208:223]
    v_mfma_f32_32x32x16_bf16 v[192:207], a[240:243], v[184:187], v[192:207]
    v_mfma_f32_32x32x16_bf16 v[208:223], a[244:247], v[184:187], v[208:223]
    v_mfma_f32_32x32x16_bf16 v[192:207], a[248:251], v[188:191], v[192:207]
    v_mfma_f32_32x32x16_bf16 v[208:223], a[252:255], v[188:191], v[208:223]
    s_nop 7
    s_nop 3
    v_cvt_pk_bf16_f32 v224, v192, v193
    v_cvt_pk_bf16_f32 v225, v194, v195
    v_cvt_pk_bf16_f32 v226, v196, v197
    v_cvt_pk_bf16_f32 v227, v198, v199
    ds_write_b128 v2, v[224:227] offset:17408
    v_cvt_pk_bf16_f32 v228, v200, v201
    v_cvt_pk_bf16_f32 v229, v202, v203
    v_cvt_pk_bf16_f32 v230, v204, v205
    v_cvt_pk_bf16_f32 v231, v206, v207
    v_xor_b32 v3, 32, v2
    ds_write_b128 v3, v[228:231] offset:17408
    v_cvt_pk_bf16_f32 v232, v208, v209
    v_cvt_pk_bf16_f32 v233, v210, v211
    v_cvt_pk_bf16_f32 v234, v212, v213
    v_cvt_pk_bf16_f32 v235, v214, v215
    v_xor_b32 v3, 64, v2
    ds_write_b128 v3, v[232:235] offset:17408
    v_cvt_pk_bf16_f32 v236, v216, v217
    v_cvt_pk_bf16_f32 v237, v218, v219
    v_cvt_pk_bf16_f32 v238, v220, v221
    v_cvt_pk_bf16_f32 v239, v222, v223
    v_xor_b32 v3, 96, v2
    ds_write_b128 v3, v[236:239] offset:17408
    s_waitcnt lgkmcnt(0)
    ds_read_b128 v[224:227], v4 offset:17408
    ds_read_b128 v[228:231], v4 offset:18432
    ds_read_b128 v[232:235], v4 offset:19456
    ds_read_b128 v[236:239], v4 offset:20480
    s_add_u32 s76, s11, 0
    s_waitcnt lgkmcnt(3)
    buffer_store_dwordx4 v[224:227], v5, s[52:55], s76 offen sc1
    s_add_u32 s73, s11, 8192
    s_waitcnt lgkmcnt(2)
    buffer_store_dwordx4 v[228:231], v5, s[52:55], s73 offen sc1
    s_add_u32 s74, s11, 16384
    s_waitcnt lgkmcnt(1)
    buffer_store_dwordx4 v[232:235], v5, s[52:55], s74 offen sc1
    s_add_u32 s75, s11, 24576
    s_waitcnt lgkmcnt(0)
    buffer_store_dwordx4 v[236:239], v5, s[52:55], s75 offen sc1
    s_waitcnt vmcnt(0)
L_end:
    s_endpgm
L_hsw_5:
    s_mov_b32 s77, 0
    v_and_b32 v2, 3, v1
    v_lshlrev_b32 v2, 6, v2
L_hsw_5_l:
    s_add_u32 s77, s77, 1
    s_cmp_ge_u32 s77, 4096
    s_cbranch_scc1 L_hsd_6
    buffer_load_dword v36, v2, s[56:59], 0 offen sc1
    s_waitcnt vmcnt(0)
    v_cmp_gt_u32 vcc, 64, v36
    s_cbranch_vccnz L_hsw_5_l
    s_branch L_hsd_6
L_s2r_8:
    s_add_u32 s77, s77, 1
    s_cmp_ge_u32 s77, 4096
    s_cbranch_scc1 L_s2k_9
    s_add_u32 s76, s4, s13
    s_sub_u32 s76, s76, 16384
    buffer_load_dwordx4 v[128:131], v9, s[60:63], s76 offen sc1
    s_add_u32 s73, s4, s13
    buffer_load_dwordx4 v[132:135], v8, s[60:63], s73 offen sc1
    s_add_u32 s74, s4, s13
    s_add_u32 s74, s74, 16384
    buffer_load_dwordx4 v[136:139], v8, s[60:63], s74 offen sc1
    s_add_u32 s75, s4, s14
    s_sub_u32 s75, s75, 16384
    buffer_load_dwordx4 v[140:143], v9, s[60:63], s75 offen sc1
    s_add_u32 s76, s4, s14
    buffer_load_dwordx4 v[144:147], v8, s[60:63], s76 offen sc1
    s_add_u32 s73, s4, s14
    s_add_u32 s73, s73, 16384
    buffer_load_dwordx4 v[148:151], v8, s[60:63], s73 offen sc1
    s_add_u32 s74, s4, s15
    s_sub_u32 s74, s74, 16384
    buffer_load_dwordx4 v[152:155], v9, s[60:63], s74 offen sc1
    s_add_u32 s75, s4, s15
    buffer_load_dwordx4 v[156:159], v8, s[60:63], s75 offen sc1
    s_add_u32 s76, s4, s15
    s_add_u32 s76, s76, 16384
    buffer_load_dwordx4 v[160:163], v8, s[60:63], s76 offen sc1
    s_add_u32 s73, s4, s16
    s_sub_u32 s73, s73, 16384
    buffer_load_dwordx4 v[164:167], v9, s[60:63], s73 offen sc1
    s_add_u32 s74, s4, s16
    buffer_load_dwordx4 v[168:171], v8, s[60:63], s74 offen sc1
    s_add_u32 s75, s4, s16
    s_add_u32 s75, s75, 16384
    buffer_load_dwordx4 v[172:175], v8, s[60:63], s75 offen sc1
    s_waitcnt vmcnt(0)
    s_branch L_s2m_7
L_gpr_10:
    s_add_u32 s77, s77, 1
    s_cmp_ge_u32 s77, 4096
    s_cbranch_scc1 L_gpk_11
    s_mov_b32 s76, 0
    buffer_load_dwordx4 v[160:163], v21, s[60:63], s76 offen sc1
    s_mov_b32 s73, 4096
    buffer_load_dwordx4 v[164:167], v21, s[60:63], s73 offen sc1
    s_mov_b32 s74, 8192
    buffer_load_dwordx4 v[168:171], v21, s[60:63], s74 offen sc1
    s_mov_b32 s75, 12288
    buffer_load_dwordx4 v[172:175], v21, s[60:63], s75 offen sc1
    s_waitcnt vmcnt(0)
    s_branch L_gpa_12
L_exf_13:
    v_and_b32 v176, 0xffff, v164
    v_lshrrev_b32 v177, 16, v164
    v_and_b32 v178, 0xffff, v165
    v_lshrrev_b32 v179, 16, v165
    v_or_b32 v176, 0x80000000, v176
    v_or_b32 v177, 0x80000000, v177
    v_or_b32 v178, 0x80000000, v178
    v_or_b32 v179, 0x80000000, v179
    v_cndmask_b32 v172, v172, v176, vcc
    v_cndmask_b32 v173, v173, v177, vcc
    v_cndmask_b32 v174, v174, v178, vcc
    v_cndmask_b32 v175, v175, v179, vcc
    s_branch L_exk_14
L_fdr_16:
    s_add_u32 s77, s77, 1
    s_cmp_ge_u32 s77, 4096
    s_cbranch_scc1 L_fdk_17
    s_add_u32 s76, s5, s13
    buffer_load_dwordx4 v[128:131], v8, s[60:63], s76 offen sc1
    s_add_u32 s73, s5, s14
    buffer_load_dwordx4 v[132:135], v8, s[60:63], s73 offen sc1
    s_add_u32 s74, s5, s15
    buffer_load_dwordx4 v[136:139], v8, s[60:63], s74 offen sc1
    s_add_u32 s75, s5, s16
    buffer_load_dwordx4 v[140:143], v8, s[60:63], s75 offen sc1
    s_waitcnt vmcnt(0)
    s_branch L_fda_15
L_exf_18:
    v_and_b32 v208, 0xffff, v196
    v_lshrrev_b32 v209, 16, v196
    v_and_b32 v210, 0xffff, v197
    v_lshrrev_b32 v211, 16, v197
    v_or_b32 v208, 0x80000000, v208
    v_or_b32 v209, 0x80000000, v209
    v_or_b32 v210, 0x80000000, v210
    v_or_b32 v211, 0x80000000, v211
    v_cndmask_b32 v204, v204, v208, vcc
    v_cndmask_b32 v205, v205, v209, vcc
    v_cndmask_b32 v206, v206, v210, vcc
    v_cndmask_b32 v207, v207, v211, vcc
    s_branch L_exk_19
L_ger_20:
    v_cmp_eq_u32 vcc, -1, v2
    s_cbranch_vccnz L_ger_20_r
    s_mov_b32 s11, 1
    s_branch L_gek_21
L_ger_20_r:
    s_add_u32 s77, s77, 1
    s_cmp_ge_u32 s77, 4096
    s_cbranch_scc1 L_gek_21
    buffer_load_dwordx4 v[160:163], v8, s[60:63], s8 offen sc1
    buffer_load_dwordx4 v[164:167], v12, s[60:63], s8 offen sc1
    buffer_load_dwordx4 v[168:171], v13, s[60:63], s8 offen sc1
    buffer_load_dwordx4 v[172:175], v14, s[60:63], s8 offen sc1
    s_waitcnt vmcnt(0)
    s_branch L_gea_22
L_fer_23:
    v_cmp_eq_u32 vcc, -1, v2
    s_cbranch_vccnz L_fer_23_r
    s_mov_b32 s11, 1
    s_branch L_fek_24
L_fer_23_r:
    s_add_u32 s77, s77, 1
    s_cmp_ge_u32 s77, 4096
    s_cbranch_scc1 L_fek_24
    buffer_load_dwordx4 v[176:179], v9, s[60:63], s7 offen sc1
    buffer_load_dwordx4 v[180:183], v20, s[60:63], s7 offen sc1
    s_waitcnt vmcnt(0)
    s_branch L_fea_25
L_exs_26:
    s_mov_b32 s11, 0x4038aa3b
    s_waitcnt lgkmcnt(0)
    ds_read_b128 v[96:99], v22 offset:38912
    ds_read_b128 v[100:103], v22 offset:38976
    ds_read_b128 v[104:107], v22 offset:39168
    ds_read_b128 v[108:111], v22 offset:39232
    ds_read_b128 v[112:115], v22 offset:39424
    ds_read_b128 v[116:119], v22 offset:39488
    ds_read_b128 v[120:123], v22 offset:39680
    ds_read_b128 v[124:127], v22 offset:39744
    ds_read_b128 v[128:131], v22 offset:39936
    ds_read_b128 v[132:135], v22 offset:40000
    ds_read_b128 v[136:139], v22 offset:40192
    ds_read_b128 v[140:143], v22 offset:40256
    ds_read_b128 v[144:147], v22 offset:40448
    ds_read_b128 v[148:151], v22 offset:40512
    ds_read_b128 v[152:155], v22 offset:40704
    ds_read_b128 v[156:159], v22 offset:40768
    s_waitcnt lgkmcnt(0)
    v_cmp_gt_i32 vcc, 0, v32
    v_log_f32 v225, v32
    v_lshlrev_b32 v224, 16, v32
    v_mul_f32 v224, s11, v224
    v_cndmask_b32 v224, v225, v224, vcc
    v_cmp_gt_i32 vcc, 0, v96
    v_log_f32 v227, v96
    v_lshlrev_b32 v226, 16, v96
    v_mul_f32 v226, s11, v226
    v_cndmask_b32 v226, v227, v226, vcc
    v_add_f32 v224, v224, v226
    s_nop 0
    v_exp_f32 v32, v224
    v_cmp_gt_i32 vcc, 0, v33
    v_log_f32 v225, v33
    v_lshlrev_b32 v224, 16, v33
    v_mul_f32 v224, s11, v224
    v_cndmask_b32 v224, v225, v224, vcc
    v_cmp_gt_i32 vcc, 0, v97
    v_log_f32 v227, v97
    v_lshlrev_b32 v226, 16, v97
    v_mul_f32 v226, s11, v226
    v_cndmask_b32 v226, v227, v226, vcc
    v_add_f32 v224, v224, v226
    s_nop 0
    v_exp_f32 v33, v224
    v_cmp_gt_i32 vcc, 0, v34
    v_log_f32 v225, v34
    v_lshlrev_b32 v224, 16, v34
    v_mul_f32 v224, s11, v224
    v_cndmask_b32 v224, v225, v224, vcc
    v_cmp_gt_i32 vcc, 0, v98
    v_log_f32 v227, v98
    v_lshlrev_b32 v226, 16, v98
    v_mul_f32 v226, s11, v226
    v_cndmask_b32 v226, v227, v226, vcc
    v_add_f32 v224, v224, v226
    s_nop 0
    v_exp_f32 v34, v224
    v_cmp_gt_i32 vcc, 0, v35
    v_log_f32 v225, v35
    v_lshlrev_b32 v224, 16, v35
    v_mul_f32 v224, s11, v224
    v_cndmask_b32 v224, v225, v224, vcc
    v_cmp_gt_i32 vcc, 0, v99
    v_log_f32 v227, v99
    v_lshlrev_b32 v226, 16, v99
    v_mul_f32 v226, s11, v226
    v_cndmask_b32 v226, v227, v226, vcc
    v_add_f32 v224, v224, v226
    s_nop 0
    v_exp_f32 v35, v224
    v_cmp_gt_i32 vcc, 0, v36
    v_log_f32 v225, v36
    v_lshlrev_b32 v224, 16, v36
    v_mul_f32 v224, s11, v224
    v_cndmask_b32 v224, v225, v224, vcc
    v_cmp_gt_i32 vcc, 0, v100
    v_log_f32 v227, v100
    v_lshlrev_b32 v226, 16, v100
    v_mul_f32 v226, s11, v226
    v_cndmask_b32 v226, v227, v226, vcc
    v_add_f32 v224, v224, v226
    s_nop 0
    v_exp_f32 v36, v224
    v_cmp_gt_i32 vcc, 0, v37
    v_log_f32 v225, v37
    v_lshlrev_b32 v224, 16, v37
    v_mul_f32 v224, s11, v224
    v_cndmask_b32 v224, v225, v224, vcc
    v_cmp_gt_i32 vcc, 0, v101
    v_log_f32 v227, v101
    v_lshlrev_b32 v226, 16, v101
    v_mul_f32 v226, s11, v226
    v_cndmask_b32 v226, v227, v226, vcc
    v_add_f32 v224, v224, v226
    s_nop 0
    v_exp_f32 v37, v224
    v_cmp_gt_i32 vcc, 0, v38
    v_log_f32 v225, v38
    v_lshlrev_b32 v224, 16, v38
    v_mul_f32 v224, s11, v224
    v_cndmask_b32 v224, v225, v224, vcc
    v_cmp_gt_i32 vcc, 0, v102
    v_log_f32 v227, v102
    v_lshlrev_b32 v226, 16, v102
    v_mul_f32 v226, s11, v226
    v_cndmask_b32 v226, v227, v226, vcc
    v_add_f32 v224, v224, v226
    s_nop 0
    v_exp_f32 v38, v224
    v_cmp_gt_i32 vcc, 0, v39
    v_log_f32 v225, v39
    v_lshlrev_b32 v224, 16, v39
    v_mul_f32 v224, s11, v224
    v_cndmask_b32 v224, v225, v224, vcc
    v_cmp_gt_i32 vcc, 0, v103
    v_log_f32 v227, v103
    v_lshlrev_b32 v226, 16, v103
    v_mul_f32 v226, s11, v226
    v_cndmask_b32 v226, v227, v226, vcc
    v_add_f32 v224, v224, v226
    s_nop 0
    v_exp_f32 v39, v224
    v_cmp_gt_i32 vcc, 0, v40
    v_log_f32 v225, v40
    v_lshlrev_b32 v224, 16, v40
    v_mul_f32 v224, s11, v224
    v_cndmask_b32 v224, v225, v224, vcc
    v_cmp_gt_i32 vcc, 0, v104
    v_log_f32 v227, v104
    v_lshlrev_b32 v226, 16, v104
    v_mul_f32 v226, s11, v226
    v_cndmask_b32 v226, v227, v226, vcc
    v_add_f32 v224, v224, v226
    s_nop 0
    v_exp_f32 v40, v224
    v_cmp_gt_i32 vcc, 0, v41
    v_log_f32 v225, v41
    v_lshlrev_b32 v224, 16, v41
    v_mul_f32 v224, s11, v224
    v_cndmask_b32 v224, v225, v224, vcc
    v_cmp_gt_i32 vcc, 0, v105
    v_log_f32 v227, v105
    v_lshlrev_b32 v226, 16, v105
    v_mul_f32 v226, s11, v226
    v_cndmask_b32 v226, v227, v226, vcc
    v_add_f32 v224, v224, v226
    s_nop 0
    v_exp_f32 v41, v224
    v_cmp_gt_i32 vcc, 0, v42
    v_log_f32 v225, v42
    v_lshlrev_b32 v224, 16, v42
    v_mul_f32 v224, s11, v224
    v_cndmask_b32 v224, v225, v224, vcc
    v_cmp_gt_i32 vcc, 0, v106
    v_log_f32 v227, v106
    v_lshlrev_b32 v226, 16, v106
    v_mul_f32 v226, s11, v226
    v_cndmask_b32 v226, v227, v226, vcc
    v_add_f32 v224, v224, v226
    s_nop 0
    v_exp_f32 v42, v224
    v_cmp_gt_i32 vcc, 0, v43
    v_log_f32 v225, v43
    v_lshlrev_b32 v224, 16, v43
    v_mul_f32 v224, s11, v224
    v_cndmask_b32 v224, v225, v224, vcc
    v_cmp_gt_i32 vcc, 0, v107
    v_log_f32 v227, v107
    v_lshlrev_b32 v226, 16, v107
    v_mul_f32 v226, s11, v226
    v_cndmask_b32 v226, v227, v226, vcc
    v_add_f32 v224, v224, v226
    s_nop 0
    v_exp_f32 v43, v224
    v_cmp_gt_i32 vcc, 0, v44
    v_log_f32 v225, v44
    v_lshlrev_b32 v224, 16, v44
    v_mul_f32 v224, s11, v224
    v_cndmask_b32 v224, v225, v224, vcc
    v_cmp_gt_i32 vcc, 0, v108
    v_log_f32 v227, v108
    v_lshlrev_b32 v226, 16, v108
    v_mul_f32 v226, s11, v226
    v_cndmask_b32 v226, v227, v226, vcc
    v_add_f32 v224, v224, v226
    s_nop 0
    v_exp_f32 v44, v224
    v_cmp_gt_i32 vcc, 0, v45
    v_log_f32 v225, v45
    v_lshlrev_b32 v224, 16, v45
    v_mul_f32 v224, s11, v224
    v_cndmask_b32 v224, v225, v224, vcc
    v_cmp_gt_i32 vcc, 0, v109
    v_log_f32 v227, v109
    v_lshlrev_b32 v226, 16, v109
    v_mul_f32 v226, s11, v226
    v_cndmask_b32 v226, v227, v226, vcc
    v_add_f32 v224, v224, v226
    s_nop 0
    v_exp_f32 v45, v224
    v_cmp_gt_i32 vcc, 0, v46
    v_log_f32 v225, v46
    v_lshlrev_b32 v224, 16, v46
    v_mul_f32 v224, s11, v224
    v_cndmask_b32 v224, v225, v224, vcc
    v_cmp_gt_i32 vcc, 0, v110
    v_log_f32 v227, v110
    v_lshlrev_b32 v226, 16, v110
    v_mul_f32 v226, s11, v226
    v_cndmask_b32 v226, v227, v226, vcc
    v_add_f32 v224, v224, v226
    s_nop 0
    v_exp_f32 v46, v224
    v_cmp_gt_i32 vcc, 0, v47
    v_log_f32 v225, v47
    v_lshlrev_b32 v224, 16, v47
    v_mul_f32 v224, s11, v224
    v_cndmask_b32 v224, v225, v224, vcc
    v_cmp_gt_i32 vcc, 0, v111
    v_log_f32 v227, v111
    v_lshlrev_b32 v226, 16, v111
    v_mul_f32 v226, s11, v226
    v_cndmask_b32 v226, v227, v226, vcc
    v_add_f32 v224, v224, v226
    s_nop 0
    v_exp_f32 v47, v224
    v_cmp_gt_i32 vcc, 0, v48
    v_log_f32 v225, v48
    v_lshlrev_b32 v224, 16, v48
    v_mul_f32 v224, s11, v224
    v_cndmask_b32 v224, v225, v224, vcc
    v_cmp_gt_i32 vcc, 0, v112
    v_log_f32 v227, v112
    v_lshlrev_b32 v226, 16, v112
    v_mul_f32 v226, s11, v226
    v_cndmask_b32 v226, v227, v226, vcc
    v_add_f32 v224, v224, v226
    s_nop 0
    v_exp_f32 v48, v224
    v_cmp_gt_i32 vcc, 0, v49
    v_log_f32 v225, v49
    v_lshlrev_b32 v224, 16, v49
    v_mul_f32 v224, s11, v224
    v_cndmask_b32 v224, v225, v224, vcc
    v_cmp_gt_i32 vcc, 0, v113
    v_log_f32 v227, v113
    v_lshlrev_b32 v226, 16, v113
    v_mul_f32 v226, s11, v226
    v_cndmask_b32 v226, v227, v226, vcc
    v_add_f32 v224, v224, v226
    s_nop 0
    v_exp_f32 v49, v224
    v_cmp_gt_i32 vcc, 0, v50
    v_log_f32 v225, v50
    v_lshlrev_b32 v224, 16, v50
    v_mul_f32 v224, s11, v224
    v_cndmask_b32 v224, v225, v224, vcc
    v_cmp_gt_i32 vcc, 0, v114
    v_log_f32 v227, v114
    v_lshlrev_b32 v226, 16, v114
    v_mul_f32 v226, s11, v226
    v_cndmask_b32 v226, v227, v226, vcc
    v_add_f32 v224, v224, v226
    s_nop 0
    v_exp_f32 v50, v224
    v_cmp_gt_i32 vcc, 0, v51
    v_log_f32 v225, v51
    v_lshlrev_b32 v224, 16, v51
    v_mul_f32 v224, s11, v224
    v_cndmask_b32 v224, v225, v224, vcc
    v_cmp_gt_i32 vcc, 0, v115
    v_log_f32 v227, v115
    v_lshlrev_b32 v226, 16, v115
    v_mul_f32 v226, s11, v226
    v_cndmask_b32 v226, v227, v226, vcc
    v_add_f32 v224, v224, v226
    s_nop 0
    v_exp_f32 v51, v224
    v_cmp_gt_i32 vcc, 0, v52
    v_log_f32 v225, v52
    v_lshlrev_b32 v224, 16, v52
    v_mul_f32 v224, s11, v224
    v_cndmask_b32 v224, v225, v224, vcc
    v_cmp_gt_i32 vcc, 0, v116
    v_log_f32 v227, v116
    v_lshlrev_b32 v226, 16, v116
    v_mul_f32 v226, s11, v226
    v_cndmask_b32 v226, v227, v226, vcc
    v_add_f32 v224, v224, v226
    s_nop 0
    v_exp_f32 v52, v224
    v_cmp_gt_i32 vcc, 0, v53
    v_log_f32 v225, v53
    v_lshlrev_b32 v224, 16, v53
    v_mul_f32 v224, s11, v224
    v_cndmask_b32 v224, v225, v224, vcc
    v_cmp_gt_i32 vcc, 0, v117
    v_log_f32 v227, v117
    v_lshlrev_b32 v226, 16, v117
    v_mul_f32 v226, s11, v226
    v_cndmask_b32 v226, v227, v226, vcc
    v_add_f32 v224, v224, v226
    s_nop 0
    v_exp_f32 v53, v224
    v_cmp_gt_i32 vcc, 0, v54
    v_log_f32 v225, v54
    v_lshlrev_b32 v224, 16, v54
    v_mul_f32 v224, s11, v224
    v_cndmask_b32 v224, v225, v224, vcc
    v_cmp_gt_i32 vcc, 0, v118
    v_log_f32 v227, v118
    v_lshlrev_b32 v226, 16, v118
    v_mul_f32 v226, s11, v226
    v_cndmask_b32 v226, v227, v226, vcc
    v_add_f32 v224, v224, v226
    s_nop 0
    v_exp_f32 v54, v224
    v_cmp_gt_i32 vcc, 0, v55
    v_log_f32 v225, v55
    v_lshlrev_b32 v224, 16, v55
    v_mul_f32 v224, s11, v224
    v_cndmask_b32 v224, v225, v224, vcc
    v_cmp_gt_i32 vcc, 0, v119
    v_log_f32 v227, v119
    v_lshlrev_b32 v226, 16, v119
    v_mul_f32 v226, s11, v226
    v_cndmask_b32 v226, v227, v226, vcc
    v_add_f32 v224, v224, v226
    s_nop 0
    v_exp_f32 v55, v224
    v_cmp_gt_i32 vcc, 0, v56
    v_log_f32 v225, v56
    v_lshlrev_b32 v224, 16, v56
    v_mul_f32 v224, s11, v224
    v_cndmask_b32 v224, v225, v224, vcc
    v_cmp_gt_i32 vcc, 0, v120
    v_log_f32 v227, v120
    v_lshlrev_b32 v226, 16, v120
    v_mul_f32 v226, s11, v226
    v_cndmask_b32 v226, v227, v226, vcc
    v_add_f32 v224, v224, v226
    s_nop 0
    v_exp_f32 v56, v224
    v_cmp_gt_i32 vcc, 0, v57
    v_log_f32 v225, v57
    v_lshlrev_b32 v224, 16, v57
    v_mul_f32 v224, s11, v224
    v_cndmask_b32 v224, v225, v224, vcc
    v_cmp_gt_i32 vcc, 0, v121
    v_log_f32 v227, v121
    v_lshlrev_b32 v226, 16, v121
    v_mul_f32 v226, s11, v226
    v_cndmask_b32 v226, v227, v226, vcc
    v_add_f32 v224, v224, v226
    s_nop 0
    v_exp_f32 v57, v224
    v_cmp_gt_i32 vcc, 0, v58
    v_log_f32 v225, v58
    v_lshlrev_b32 v224, 16, v58
    v_mul_f32 v224, s11, v224
    v_cndmask_b32 v224, v225, v224, vcc
    v_cmp_gt_i32 vcc, 0, v122
    v_log_f32 v227, v122
    v_lshlrev_b32 v226, 16, v122
    v_mul_f32 v226, s11, v226
    v_cndmask_b32 v226, v227, v226, vcc
    v_add_f32 v224, v224, v226
    s_nop 0
    v_exp_f32 v58, v224
    v_cmp_gt_i32 vcc, 0, v59
    v_log_f32 v225, v59
    v_lshlrev_b32 v224, 16, v59
    v_mul_f32 v224, s11, v224
    v_cndmask_b32 v224, v225, v224, vcc
    v_cmp_gt_i32 vcc, 0, v123
    v_log_f32 v227, v123
    v_lshlrev_b32 v226, 16, v123
    v_mul_f32 v226, s11, v226
    v_cndmask_b32 v226, v227, v226, vcc
    v_add_f32 v224, v224, v226
    s_nop 0
    v_exp_f32 v59, v224
    v_cmp_gt_i32 vcc, 0, v60
    v_log_f32 v225, v60
    v_lshlrev_b32 v224, 16, v60
    v_mul_f32 v224, s11, v224
    v_cndmask_b32 v224, v225, v224, vcc
    v_cmp_gt_i32 vcc, 0, v124
    v_log_f32 v227, v124
    v_lshlrev_b32 v226, 16, v124
    v_mul_f32 v226, s11, v226
    v_cndmask_b32 v226, v227, v226, vcc
    v_add_f32 v224, v224, v226
    s_nop 0
    v_exp_f32 v60, v224
    v_cmp_gt_i32 vcc, 0, v61
    v_log_f32 v225, v61
    v_lshlrev_b32 v224, 16, v61
    v_mul_f32 v224, s11, v224
    v_cndmask_b32 v224, v225, v224, vcc
    v_cmp_gt_i32 vcc, 0, v125
    v_log_f32 v227, v125
    v_lshlrev_b32 v226, 16, v125
    v_mul_f32 v226, s11, v226
    v_cndmask_b32 v226, v227, v226, vcc
    v_add_f32 v224, v224, v226
    s_nop 0
    v_exp_f32 v61, v224
    v_cmp_gt_i32 vcc, 0, v62
    v_log_f32 v225, v62
    v_lshlrev_b32 v224, 16, v62
    v_mul_f32 v224, s11, v224
    v_cndmask_b32 v224, v225, v224, vcc
    v_cmp_gt_i32 vcc, 0, v126
    v_log_f32 v227, v126
    v_lshlrev_b32 v226, 16, v126
    v_mul_f32 v226, s11, v226
    v_cndmask_b32 v226, v227, v226, vcc
    v_add_f32 v224, v224, v226
    s_nop 0
    v_exp_f32 v62, v224
    v_cmp_gt_i32 vcc, 0, v63
    v_log_f32 v225, v63
    v_lshlrev_b32 v224, 16, v63
    v_mul_f32 v224, s11, v224
    v_cndmask_b32 v224, v225, v224, vcc
    v_cmp_gt_i32 vcc, 0, v127
    v_log_f32 v227, v127
    v_lshlrev_b32 v226, 16, v127
    v_mul_f32 v226, s11, v226
    v_cndmask_b32 v226, v227, v226, vcc
    v_add_f32 v224, v224, v226
    s_nop 0
    v_exp_f32 v63, v224
    v_cmp_gt_i32 vcc, 0, v64
    v_log_f32 v225, v64
    v_lshlrev_b32 v224, 16, v64
    v_mul_f32 v224, s11, v224
    v_cndmask_b32 v224, v225, v224, vcc
    v_cmp_gt_i32 vcc, 0, v128
    v_log_f32 v227, v128
    v_lshlrev_b32 v226, 16, v128
    v_mul_f32 v226, s11, v226
    v_cndmask_b32 v226, v227, v226, vcc
    v_add_f32 v224, v224, v226
    s_nop 0
    v_exp_f32 v64, v224
    v_cmp_gt_i32 vcc, 0, v65
    v_log_f32 v225, v65
    v_lshlrev_b32 v224, 16, v65
    v_mul_f32 v224, s11, v224
    v_cndmask_b32 v224, v225, v224, vcc
    v_cmp_gt_i32 vcc, 0, v129
    v_log_f32 v227, v129
    v_lshlrev_b32 v226, 16, v129
    v_mul_f32 v226, s11, v226
    v_cndmask_b32 v226, v227, v226, vcc
    v_add_f32 v224, v224, v226
    s_nop 0
    v_exp_f32 v65, v224
    v_cmp_gt_i32 vcc, 0, v66
    v_log_f32 v225, v66
    v_lshlrev_b32 v224, 16, v66
    v_mul_f32 v224, s11, v224
    v_cndmask_b32 v224, v225, v224, vcc
    v_cmp_gt_i32 vcc, 0, v130
    v_log_f32 v227, v130
    v_lshlrev_b32 v226, 16, v130
    v_mul_f32 v226, s11, v226
    v_cndmask_b32 v226, v227, v226, vcc
    v_add_f32 v224, v224, v226
    s_nop 0
    v_exp_f32 v66, v224
    v_cmp_gt_i32 vcc, 0, v67
    v_log_f32 v225, v67
    v_lshlrev_b32 v224, 16, v67
    v_mul_f32 v224, s11, v224
    v_cndmask_b32 v224, v225, v224, vcc
    v_cmp_gt_i32 vcc, 0, v131
    v_log_f32 v227, v131
    v_lshlrev_b32 v226, 16, v131
    v_mul_f32 v226, s11, v226
    v_cndmask_b32 v226, v227, v226, vcc
    v_add_f32 v224, v224, v226
    s_nop 0
    v_exp_f32 v67, v224
    v_cmp_gt_i32 vcc, 0, v68
    v_log_f32 v225, v68
    v_lshlrev_b32 v224, 16, v68
    v_mul_f32 v224, s11, v224
    v_cndmask_b32 v224, v225, v224, vcc
    v_cmp_gt_i32 vcc, 0, v132
    v_log_f32 v227, v132
    v_lshlrev_b32 v226, 16, v132
    v_mul_f32 v226, s11, v226
    v_cndmask_b32 v226, v227, v226, vcc
    v_add_f32 v224, v224, v226
    s_nop 0
    v_exp_f32 v68, v224
    v_cmp_gt_i32 vcc, 0, v69
    v_log_f32 v225, v69
    v_lshlrev_b32 v224, 16, v69
    v_mul_f32 v224, s11, v224
    v_cndmask_b32 v224, v225, v224, vcc
    v_cmp_gt_i32 vcc, 0, v133
    v_log_f32 v227, v133
    v_lshlrev_b32 v226, 16, v133
    v_mul_f32 v226, s11, v226
    v_cndmask_b32 v226, v227, v226, vcc
    v_add_f32 v224, v224, v226
    s_nop 0
    v_exp_f32 v69, v224
    v_cmp_gt_i32 vcc, 0, v70
    v_log_f32 v225, v70
    v_lshlrev_b32 v224, 16, v70
    v_mul_f32 v224, s11, v224
    v_cndmask_b32 v224, v225, v224, vcc
    v_cmp_gt_i32 vcc, 0, v134
    v_log_f32 v227, v134
    v_lshlrev_b32 v226, 16, v134
    v_mul_f32 v226, s11, v226
    v_cndmask_b32 v226, v227, v226, vcc
    v_add_f32 v224, v224, v226
    s_nop 0
    v_exp_f32 v70, v224
    v_cmp_gt_i32 vcc, 0, v71
    v_log_f32 v225, v71
    v_lshlrev_b32 v224, 16, v71
    v_mul_f32 v224, s11, v224
    v_cndmask_b32 v224, v225, v224, vcc
    v_cmp_gt_i32 vcc, 0, v135
    v_log_f32 v227, v135
    v_lshlrev_b32 v226, 16, v135
    v_mul_f32 v226, s11, v226
    v_cndmask_b32 v226, v227, v226, vcc
    v_add_f32 v224, v224, v226
    s_nop 0
    v_exp_f32 v71, v224
    v_cmp_gt_i32 vcc, 0, v72
    v_log_f32 v225, v72
    v_lshlrev_b32 v224, 16, v72
    v_mul_f32 v224, s11, v224
    v_cndmask_b32 v224, v225, v224, vcc
    v_cmp_gt_i32 vcc, 0, v136
    v_log_f32 v227, v136
    v_lshlrev_b32 v226, 16, v136
    v_mul_f32 v226, s11, v226
    v_cndmask_b32 v226, v227, v226, vcc
    v_add_f32 v224, v224, v226
    s_nop 0
    v_exp_f32 v72, v224
    v_cmp_gt_i32 vcc, 0, v73
    v_log_f32 v225, v73
    v_lshlrev_b32 v224, 16, v73
    v_mul_f32 v224, s11, v224
    v_cndmask_b32 v224, v225, v224, vcc
    v_cmp_gt_i32 vcc, 0, v137
    v_log_f32 v227, v137
    v_lshlrev_b32 v226, 16, v137
    v_mul_f32 v226, s11, v226
    v_cndmask_b32 v226, v227, v226, vcc
    v_add_f32 v224, v224, v226
    s_nop 0
    v_exp_f32 v73, v224
    v_cmp_gt_i32 vcc, 0, v74
    v_log_f32 v225, v74
    v_lshlrev_b32 v224, 16, v74
    v_mul_f32 v224, s11, v224
    v_cndmask_b32 v224, v225, v224, vcc
    v_cmp_gt_i32 vcc, 0, v138
    v_log_f32 v227, v138
    v_lshlrev_b32 v226, 16, v138
    v_mul_f32 v226, s11, v226
    v_cndmask_b32 v226, v227, v226, vcc
    v_add_f32 v224, v224, v226
    s_nop 0
    v_exp_f32 v74, v224
    v_cmp_gt_i32 vcc, 0, v75
    v_log_f32 v225, v75
    v_lshlrev_b32 v224, 16, v75
    v_mul_f32 v224, s11, v224
    v_cndmask_b32 v224, v225, v224, vcc
    v_cmp_gt_i32 vcc, 0, v139
    v_log_f32 v227, v139
    v_lshlrev_b32 v226, 16, v139
    v_mul_f32 v226, s11, v226
    v_cndmask_b32 v226, v227, v226, vcc
    v_add_f32 v224, v224, v226
    s_nop 0
    v_exp_f32 v75, v224
    v_cmp_gt_i32 vcc, 0, v76
    v_log_f32 v225, v76
    v_lshlrev_b32 v224, 16, v76
    v_mul_f32 v224, s11, v224
    v_cndmask_b32 v224, v225, v224, vcc
    v_cmp_gt_i32 vcc, 0, v140
    v_log_f32 v227, v140
    v_lshlrev_b32 v226, 16, v140
    v_mul_f32 v226, s11, v226
    v_cndmask_b32 v226, v227, v226, vcc
    v_add_f32 v224, v224, v226
    s_nop 0
    v_exp_f32 v76, v224
    v_cmp_gt_i32 vcc, 0, v77
    v_log_f32 v225, v77
    v_lshlrev_b32 v224, 16, v77
    v_mul_f32 v224, s11, v224
    v_cndmask_b32 v224, v225, v224, vcc
    v_cmp_gt_i32 vcc, 0, v141
    v_log_f32 v227, v141
    v_lshlrev_b32 v226, 16, v141
    v_mul_f32 v226, s11, v226
    v_cndmask_b32 v226, v227, v226, vcc
    v_add_f32 v224, v224, v226
    s_nop 0
    v_exp_f32 v77, v224
    v_cmp_gt_i32 vcc, 0, v78
    v_log_f32 v225, v78
    v_lshlrev_b32 v224, 16, v78
    v_mul_f32 v224, s11, v224
    v_cndmask_b32 v224, v225, v224, vcc
    v_cmp_gt_i32 vcc, 0, v142
    v_log_f32 v227, v142
    v_lshlrev_b32 v226, 16, v142
    v_mul_f32 v226, s11, v226
    v_cndmask_b32 v226, v227, v226, vcc
    v_add_f32 v224, v224, v226
    s_nop 0
    v_exp_f32 v78, v224
    v_cmp_gt_i32 vcc, 0, v79
    v_log_f32 v225, v79
    v_lshlrev_b32 v224, 16, v79
    v_mul_f32 v224, s11, v224
    v_cndmask_b32 v224, v225, v224, vcc
    v_cmp_gt_i32 vcc, 0, v143
    v_log_f32 v227, v143
    v_lshlrev_b32 v226, 16, v143
    v_mul_f32 v226, s11, v226
    v_cndmask_b32 v226, v227, v226, vcc
    v_add_f32 v224, v224, v226
    s_nop 0
    v_exp_f32 v79, v224
    v_cmp_gt_i32 vcc, 0, v80
    v_log_f32 v225, v80
    v_lshlrev_b32 v224, 16, v80
    v_mul_f32 v224, s11, v224
    v_cndmask_b32 v224, v225, v224, vcc
    v_cmp_gt_i32 vcc, 0, v144
    v_log_f32 v227, v144
    v_lshlrev_b32 v226, 16, v144
    v_mul_f32 v226, s11, v226
    v_cndmask_b32 v226, v227, v226, vcc
    v_add_f32 v224, v224, v226
    s_nop 0
    v_exp_f32 v80, v224
    v_cmp_gt_i32 vcc, 0, v81
    v_log_f32 v225, v81
    v_lshlrev_b32 v224, 16, v81
    v_mul_f32 v224, s11, v224
    v_cndmask_b32 v224, v225, v224, vcc
    v_cmp_gt_i32 vcc, 0, v145
    v_log_f32 v227, v145
    v_lshlrev_b32 v226, 16, v145
    v_mul_f32 v226, s11, v226
    v_cndmask_b32 v226, v227, v226, vcc
    v_add_f32 v224, v224, v226
    s_nop 0
    v_exp_f32 v81, v224
    v_cmp_gt_i32 vcc, 0, v82
    v_log_f32 v225, v82
    v_lshlrev_b32 v224, 16, v82
    v_mul_f32 v224, s11, v224
    v_cndmask_b32 v224, v225, v224, vcc
    v_cmp_gt_i32 vcc, 0, v146
    v_log_f32 v227, v146
    v_lshlrev_b32 v226, 16, v146
    v_mul_f32 v226, s11, v226
    v_cndmask_b32 v226, v227, v226, vcc
    v_add_f32 v224, v224, v226
    s_nop 0
    v_exp_f32 v82, v224
    v_cmp_gt_i32 vcc, 0, v83
    v_log_f32 v225, v83
    v_lshlrev_b32 v224, 16, v83
    v_mul_f32 v224, s11, v224
    v_cndmask_b32 v224, v225, v224, vcc
    v_cmp_gt_i32 vcc, 0, v147
    v_log_f32 v227, v147
    v_lshlrev_b32 v226, 16, v147
    v_mul_f32 v226, s11, v226
    v_cndmask_b32 v226, v227, v226, vcc
    v_add_f32 v224, v224, v226
    s_nop 0
    v_exp_f32 v83, v224
    v_cmp_gt_i32 vcc, 0, v84
    v_log_f32 v225, v84
    v_lshlrev_b32 v224, 16, v84
    v_mul_f32 v224, s11, v224
    v_cndmask_b32 v224, v225, v224, vcc
    v_cmp_gt_i32 vcc, 0, v148
    v_log_f32 v227, v148
    v_lshlrev_b32 v226, 16, v148
    v_mul_f32 v226, s11, v226
    v_cndmask_b32 v226, v227, v226, vcc
    v_add_f32 v224, v224, v226
    s_nop 0
    v_exp_f32 v84, v224
    v_cmp_gt_i32 vcc, 0, v85
    v_log_f32 v225, v85
    v_lshlrev_b32 v224, 16, v85
    v_mul_f32 v224, s11, v224
    v_cndmask_b32 v224, v225, v224, vcc
    v_cmp_gt_i32 vcc, 0, v149
    v_log_f32 v227, v149
    v_lshlrev_b32 v226, 16, v149
    v_mul_f32 v226, s11, v226
    v_cndmask_b32 v226, v227, v226, vcc
    v_add_f32 v224, v224, v226
    s_nop 0
    v_exp_f32 v85, v224
    v_cmp_gt_i32 vcc, 0, v86
    v_log_f32 v225, v86
    v_lshlrev_b32 v224, 16, v86
    v_mul_f32 v224, s11, v224
    v_cndmask_b32 v224, v225, v224, vcc
    v_cmp_gt_i32 vcc, 0, v150
    v_log_f32 v227, v150
    v_lshlrev_b32 v226, 16, v150
    v_mul_f32 v226, s11, v226
    v_cndmask_b32 v226, v227, v226, vcc
    v_add_f32 v224, v224, v226
    s_nop 0
    v_exp_f32 v86, v224
    v_cmp_gt_i32 vcc, 0, v87
    v_log_f32 v225, v87
    v_lshlrev_b32 v224, 16, v87
    v_mul_f32 v224, s11, v224
    v_cndmask_b32 v224, v225, v224, vcc
    v_cmp_gt_i32 vcc, 0, v151
    v_log_f32 v227, v151
    v_lshlrev_b32 v226, 16, v151
    v_mul_f32 v226, s11, v226
    v_cndmask_b32 v226, v227, v226, vcc
    v_add_f32 v224, v224, v226
    s_nop 0
    v_exp_f32 v87, v224
    v_cmp_gt_i32 vcc, 0, v88
    v_log_f32 v225, v88
    v_lshlrev_b32 v224, 16, v88
    v_mul_f32 v224, s11, v224
    v_cndmask_b32 v224, v225, v224, vcc
    v_cmp_gt_i32 vcc, 0, v152
    v_log_f32 v227, v152
    v_lshlrev_b32 v226, 16, v152
    v_mul_f32 v226, s11, v226
    v_cndmask_b32 v226, v227, v226, vcc
    v_add_f32 v224, v224, v226
    s_nop 0
    v_exp_f32 v88, v224
    v_cmp_gt_i32 vcc, 0, v89
    v_log_f32 v225, v89
    v_lshlrev_b32 v224, 16, v89
    v_mul_f32 v224, s11, v224
    v_cndmask_b32 v224, v225, v224, vcc
    v_cmp_gt_i32 vcc, 0, v153
    v_log_f32 v227, v153
    v_lshlrev_b32 v226, 16, v153
    v_mul_f32 v226, s11, v226
    v_cndmask_b32 v226, v227, v226, vcc
    v_add_f32 v224, v224, v226
    s_nop 0
    v_exp_f32 v89, v224
    v_cmp_gt_i32 vcc, 0, v90
    v_log_f32 v225, v90
    v_lshlrev_b32 v224, 16, v90
    v_mul_f32 v224, s11, v224
    v_cndmask_b32 v224, v225, v224, vcc
    v_cmp_gt_i32 vcc, 0, v154
    v_log_f32 v227, v154
    v_lshlrev_b32 v226, 16, v154
    v_mul_f32 v226, s11, v226
    v_cndmask_b32 v226, v227, v226, vcc
    v_add_f32 v224, v224, v226
    s_nop 0
    v_exp_f32 v90, v224
    v_cmp_gt_i32 vcc, 0, v91
    v_log_f32 v225, v91
    v_lshlrev_b32 v224, 16, v91
    v_mul_f32 v224, s11, v224
    v_cndmask_b32 v224, v225, v224, vcc
    v_cmp_gt_i32 vcc, 0, v155
    v_log_f32 v227, v155
    v_lshlrev_b32 v226, 16, v155
    v_mul_f32 v226, s11, v226
    v_cndmask_b32 v226, v227, v226, vcc
    v_add_f32 v224, v224, v226
    s_nop 0
    v_exp_f32 v91, v224
    v_cmp_gt_i32 vcc, 0, v92
    v_log_f32 v225, v92
    v_lshlrev_b32 v224, 16, v92
    v_mul_f32 v224, s11, v224
    v_cndmask_b32 v224, v225, v224, vcc
    v_cmp_gt_i32 vcc, 0, v156
    v_log_f32 v227, v156
    v_lshlrev_b32 v226, 16, v156
    v_mul_f32 v226, s11, v226
    v_cndmask_b32 v226, v227, v226, vcc
    v_add_f32 v224, v224, v226
    s_nop 0
    v_exp_f32 v92, v224
    v_cmp_gt_i32 vcc, 0, v93
    v_log_f32 v225, v93
    v_lshlrev_b32 v224, 16, v93
    v_mul_f32 v224, s11, v224
    v_cndmask_b32 v224, v225, v224, vcc
    v_cmp_gt_i32 vcc, 0, v157
    v_log_f32 v227, v157
    v_lshlrev_b32 v226, 16, v157
    v_mul_f32 v226, s11, v226
    v_cndmask_b32 v226, v227, v226, vcc
    v_add_f32 v224, v224, v226
    s_nop 0
    v_exp_f32 v93, v224
    v_cmp_gt_i32 vcc, 0, v94
    v_log_f32 v225, v94
    v_lshlrev_b32 v224, 16, v94
    v_mul_f32 v224, s11, v224
    v_cndmask_b32 v224, v225, v224, vcc
    v_cmp_gt_i32 vcc, 0, v158
    v_log_f32 v227, v158
    v_lshlrev_b32 v226, 16, v158
    v_mul_f32 v226, s11, v226
    v_cndmask_b32 v226, v227, v226, vcc
    v_add_f32 v224, v224, v226
    s_nop 0
    v_exp_f32 v94, v224
    v_cmp_gt_i32 vcc, 0, v95
    v_log_f32 v225, v95
    v_lshlrev_b32 v224, 16, v95
    v_mul_f32 v224, s11, v224
    v_cndmask_b32 v224, v225, v224, vcc
    v_cmp_gt_i32 vcc, 0, v159
    v_log_f32 v227, v159
    v_lshlrev_b32 v226, 16, v159
    v_mul_f32 v226, s11, v226
    v_cndmask_b32 v226, v227, v226, vcc
    v_add_f32 v224, v224, v226
    s_nop 0
    v_exp_f32 v95, v224
    v_mov_b32 v228, 1.0
    v_mov_b32 v229, 1.0
    v_mov_b32 v230, 1.0
    v_mov_b32 v231, 1.0
    ds_write_b128 v6, v[228:231] offset:38912
    ds_write_b128 v6, v[228:231] offset:39936
    s_branch L_exq_27
L_last:
    s_endpgm

.section .rodata,"a"
.p2align 6
.amdhsa_kernel standalone__seq2seq_rnn_t_joint__speech_kernel
  .amdhsa_next_free_vgpr 512
  .amdhsa_next_free_sgpr 102
  .amdhsa_accum_offset 256
  .amdhsa_group_segment_fixed_size 0
  .amdhsa_kernarg_size 80
  .amdhsa_user_sgpr_count 2
  .amdhsa_user_sgpr_kernarg_segment_ptr 1
  .amdhsa_system_sgpr_workgroup_id_x 1
.end_amdhsa_kernel
```
